```python
import torch

def _softmax(x, axis=-1):
    return torch.softmax(x, dim=axis)

def _gelu(x):
    return torch.nn.functional.gelu(x, approximate='tanh')

def _silu(x):
    return torch.nn.functional.silu(x)

def _sigmoid(x):
    return torch.sigmoid(x)

def _layernorm(x, axis=-1, eps=1e-05):
    m = x.mean(dim=axis, keepdim=True)
    v = x.var(dim=axis, keepdim=True, unbiased=False)
    return (x - m) / torch.sqrt(v + eps)

def _scatter_add(tgt, idx, src, axis=0):
    return tgt.clone().index_add_(axis, idx, src)

def _segment_sum(src, seg, n):
    out = torch.zeros((n,) + src.shape[1:], dtype=src.dtype)
    return out.index_add_(0, seg, src)

def _pad(x, pw):
    flat = tuple((v for pair in reversed(pw) for v in pair))
    return torch.nn.functional.pad(x, flat)
kernel_name = 'gated_mix__sliding_local_dilated__mixer_gmlp__prompt'

def setup_inputs():

    _w = lambda a: (lambda t: t.to(torch.bfloat16) if t.is_floating_point() else t)(torch.as_tensor(a))

    def _A_setup():
        B, S, D = (1, 2048, 512)
        return {'x': _w((lambda *s: torch.randn(*s, dtype=torch.bfloat16) * 0.05)(B, S, D)), 'wqkv': _w((lambda *s: torch.randn(*s, dtype=torch.bfloat16) * 0.8)(D, 3 * D)), 'wo': _w((lambda *s: torch.randn(*s, dtype=torch.bfloat16) * 0.05)(D, D))}
    _A_in = _A_setup()

    def _B_setup():
        B, S, D, F = (1, 2048, 512, 1376)
        Fh = F // 2
        return {'x': _w((lambda *s: torch.randn(*s, dtype=torch.bfloat16) * 0.05)(B, S, D)), 'w_in': _w((lambda *s: torch.randn(*s, dtype=torch.bfloat16) * 0.4)(D, 2 * Fh)), 'w_sp': _w(0.01 * (lambda *s: torch.randn(*s, dtype=torch.bfloat16) * 0.4)(S, S)), 'b_sp': _w(1.0 + 0.01 * (lambda *s: torch.randn(*s, dtype=torch.bfloat16) * 0.1)(S)), 'w_out': _w((lambda *s: torch.randn(*s, dtype=torch.bfloat16) * 0.1)(Fh, D))}
    _B_in = _B_setup()
    return {'A_x': _A_in['x'], 'A_wqkv': _A_in['wqkv'], 'A_wo': _A_in['wo'], 'B_x': _B_in['x'], 'B_w_in': _B_in['w_in'], 'B_w_sp': _B_in['w_sp'], 'B_b_sp': _B_in['b_sp'], 'B_w_out': _B_in['w_out'], 'gate_w': _w((lambda *s: torch.randn(*s, dtype=torch.bfloat16) * 0.05)(512) * 16.0)}

def reference(A_x, A_wqkv, A_wo, B_x, B_w_in, B_w_sp, B_b_sp, B_w_out, gate_w):

    def _A_ref(x, wqkv, wo):
        B, S, D = x.shape
        H = 32
        Dh = D // H
        W, dil = (8, 2)
        qkv = (lambda x, *d: x.permute(*d))((x @ wqkv).reshape(B, S, 3, H, Dh), 2, 0, 3, 1, 4)
        q, k, v = (qkv[0], qkv[1], qkv[2])
        scale = Dh ** (-0.5)
        pos = torch.arange(S)
        off = torch.arange(W) * dil
        idx = pos[:, None] - off[None, :]
        mask = idx >= 0
        idx_c = torch.where(mask, idx, 0).reshape(-1)
        kg = k[:, :, idx_c, :].reshape(B, H, S, W, Dh)
        vg = v[:, :, idx_c, :].reshape(B, H, S, W, Dh)
        logits = torch.einsum('bhsd,bhswd->bhsw', q, kg) * scale
        logits = torch.where(mask[None, None, :, :], logits, -1000000000.0)
        attn = _softmax(logits, axis=-1)
        o = torch.einsum('bhsw,bhswd->bhsd', attn, vg)
        return (lambda x, *d: x.permute(*d))(o, 0, 2, 1, 3).reshape(B, S, D) @ wo

    def _B_ref(x, w_in, w_sp, b_sp, w_out):
        B, S, D = x.shape
        F = w_in.shape[-1]
        Fh = F // 2
        z = _gelu(torch.einsum('bsd,df->bsf', x, w_in))
        z1 = z[..., :Fh].clone()
        z2 = _layernorm(z[..., Fh:], axis=-1)
        g = torch.einsum('ts,bsf->btf', w_sp, z2) + b_sp[None, :, None]
        return torch.einsum('bsf,fd->bsd', z1 * g, w_out)
    x = A_x
    g = _sigmoid((x * gate_w).sum(-1, keepdims=True))
    a = _A_ref(x, A_wqkv, A_wo)
    b = _B_ref(x, B_w_in, B_w_sp, B_b_sp, B_w_out)
    return g * a + (1 - g) * b
```

```asm
; @launch kernel=k1_kernel grid=(256,1,1) block=(768,1,1) lds=129024
; @launch kernel=k2_kernel grid=(256,1,1) block=(512,1,1) lds=163840
; @launch kernel=gated_mix__sliding_local_dilated__mixer_gmlp__prompt_kernel grid=(256,1,1) block=(512,1,1) lds=131072
.amdgcn_target "amdgcn-amd-amdhsa--gfx950"
.text
.globl k1_kernel
.p2align 8
.type k1_kernel,@function
k1_kernel:
  s_cmp_ge_u32 s2, 256
  s_cbranch_scc1 k1_end
  s_load_dwordx4 s[4:7], s[0:1], 0
  s_load_dwordx2 s[8:9], s[0:1], 32
  s_load_dwordx2 s[10:11], s[0:1], 64
  s_load_dwordx4 s[60:63], s[0:1], 80
  v_and_b32 v1, 63, v0
  v_lshrrev_b32 v2, 6, v0
  s_nop 0
  v_readfirstlane_b32 s24, v2
  s_and_b32 s46, s2, 7
  s_lshr_b32 s47, s2, 3
  s_lshr_b32 s27, s47, 4
  s_lshr_b32 s28, s47, 1
  s_and_b32 s28, s28, 7
  s_lshr_b32 s48, s46, 2
  s_lshl_b32 s48, s48, 3
  s_add_u32 s28, s28, s48
  s_and_b32 s29, s46, 3
  s_lshl_b32 s29, s29, 1
  s_and_b32 s48, s47, 1
  s_add_u32 s29, s29, s48
  v_and_b32 v13, 15, v1
  v_lshrrev_b32 v14, 4, v1
  s_waitcnt lgkmcnt(0)
  s_mov_b32 s12, s4
  s_and_b32 s13, s5, 0xffff
  s_mov_b32 s14, 2097152
  s_mov_b32 s15, 0x00020000
  s_mov_b32 s20, s62
  s_and_b32 s21, s63, 0xffff
  s_mov_b32 s22, 268435456
  s_mov_b32 s23, 0x00020000
  s_cmp_ge_u32 s24, 8
  s_cbranch_scc1 k1_load
  s_cmp_eq_u32 s27, 0
  s_cbranch_scc0 k1_zc
  s_load_dwordx2 s[76:77], s[0:1], 16
  s_load_dwordx2 s[78:79], s[0:1], 40
  s_load_dwordx2 s[80:81], s[0:1], 56
  s_lshl_b32 s48, s2, 3
  s_add_u32 s48, s48, s24
  s_lshl_b32 s75, s48, 10
  v_lshlrev_b32 v160, 4, v1
  buffer_load_dwordx4 v[164:167], v160, s[12:15], s75 offen
  s_mov_b32 s84, s6
  s_and_b32 s85, s7, 0xffff
  s_mov_b32 s86, 1572864
  s_mov_b32 s87, 0x00020000
  buffer_load_dwordx4 v[164:167], v160, s[84:87], s75 offen
  s_mov_b32 s84, s8
  s_and_b32 s85, s9, 0xffff
  s_mov_b32 s86, 1409024
  s_mov_b32 s87, 0x00020000
  buffer_load_dwordx4 v[164:167], v160, s[84:87], s75 offen
  s_waitcnt lgkmcnt(0)
  s_and_b32 s25, s24, 3
  s_lshr_b32 s26, s24, 2
  s_cmp_eq_u32 s26, 0
  s_cselect_b32 s31, 1, 0
  v_and_b32 v15, 7, v13
  v_xor_b32 v15, v15, v14
  v_lshlrev_b32 v15, 4, v15
  v_lshl_add_u32 v15, v13, 7, v15
  s_lshl_b32 s48, s26, 13
  v_add_u32 v4, s48, v15
  v_xor_b32 v7, 64, v4
  v_add_u32 v5, 43008, v4
  v_add_u32 v8, 43008, v7
  v_add_u32 v6, 86016, v4
  v_add_u32 v9, 86016, v7
  v_bfe_u32 v15, v1, 2, 2
  v_and_b32 v10, 1, v14
  v_lshlrev_b32 v10, 1, v10
  v_lshrrev_b32 v11, 1, v15
  v_or_b32 v10, v10, v11
  v_lshlrev_b32 v10, 1, v10
  v_bfe_u32 v11, v1, 1, 1
  s_lshl_b32 s48, s25, 1
  v_add_u32 v11, s48, v11
  v_xor_b32 v10, v10, v11
  v_lshlrev_b32 v10, 4, v10
  v_lshl_add_u32 v10, v14, 10, v10
  v_lshl_add_u32 v10, v15, 7, v10
  v_and_b32 v11, 1, v1
  v_lshl_add_u32 v10, v11, 3, v10
  v_add_u32 v11, 43008, v10
  v_add_u32 v12, 86016, v10
  v_mov_b32 v16, 0
  v_mov_b32 v17, 0
  v_mov_b32 v18, 0
  v_mov_b32 v19, 0
  v_mov_b32 v20, 0
  v_mov_b32 v21, 0
  v_mov_b32 v22, 0
  v_mov_b32 v23, 0
  v_mov_b32 v24, 0
  v_mov_b32 v25, 0
  v_mov_b32 v26, 0
  v_mov_b32 v27, 0
  v_mov_b32 v28, 0
  v_mov_b32 v29, 0
  v_mov_b32 v30, 0
  v_mov_b32 v31, 0
  v_mov_b32 v32, 0
  v_mov_b32 v33, 0
  v_mov_b32 v34, 0
  v_mov_b32 v35, 0
  v_mov_b32 v36, 0
  v_mov_b32 v37, 0
  v_mov_b32 v38, 0
  v_mov_b32 v39, 0
  v_mov_b32 v40, 0
  v_mov_b32 v41, 0
  v_mov_b32 v42, 0
  v_mov_b32 v43, 0
  v_mov_b32 v44, 0
  v_mov_b32 v45, 0
  v_mov_b32 v46, 0
  v_mov_b32 v47, 0
  v_mov_b32 v48, 0
  v_mov_b32 v49, 0
  v_mov_b32 v50, 0
  v_mov_b32 v51, 0
  v_mov_b32 v52, 0
  v_mov_b32 v53, 0
  v_mov_b32 v54, 0
  v_mov_b32 v55, 0
  v_mov_b32 v56, 0
  v_mov_b32 v57, 0
  v_mov_b32 v58, 0
  v_mov_b32 v59, 0
  v_mov_b32 v60, 0
  v_mov_b32 v61, 0
  v_mov_b32 v62, 0
  v_mov_b32 v63, 0
  v_mov_b32 v64, 0
  v_mov_b32 v65, 0
  v_mov_b32 v66, 0
  v_mov_b32 v67, 0
  v_mov_b32 v68, 0
  v_mov_b32 v69, 0
  v_mov_b32 v70, 0
  v_mov_b32 v71, 0
  v_mov_b32 v72, 0
  v_mov_b32 v73, 0
  v_mov_b32 v74, 0
  v_mov_b32 v75, 0
  s_barrier
  s_cmp_eq_u32 s31, 0
  s_cbranch_scc1 k1x_1
  ds_read_b128 v[92:95], v4 offset:0
k1x_1:
  ds_read_b64_tr_b16 v[116:117], v10 offset:18432
  ds_read_b64_tr_b16 v[118:119], v10 offset:18944
  ds_read_b64_tr_b16 v[120:121], v10 offset:26624
  ds_read_b64_tr_b16 v[122:123], v10 offset:27136
  ds_read_b64_tr_b16 v[124:125], v10 offset:34816
  ds_read_b64_tr_b16 v[126:127], v10 offset:35328
  ds_read_b128 v[76:79], v4 offset:2048
  ds_read_b128 v[80:83], v4 offset:4096
  ds_read_b128 v[84:87], v4 offset:6144
  ds_read_b128 v[88:91], v4 offset:8192
  s_mov_b32 s84, s78
  s_and_b32 s85, s79, 0xffff
  s_mov_b32 s86, 8388608
  s_mov_b32 s87, 0x00020000
  s_add_u32 s48, s75, 0
  buffer_load_dwordx4 v[164:167], v160, s[84:87], s48 offen
  s_cmp_eq_u32 s31, 0
  s_cbranch_scc1 k1x_2
  ds_read_b128 v[112:115], v7 offset:0
k1x_2:
  ds_read_b64_tr_b16 v[128:129], v10 offset:22528
  ds_read_b64_tr_b16 v[130:131], v10 offset:23040
  ds_read_b64_tr_b16 v[132:133], v10 offset:30720
  ds_read_b64_tr_b16 v[134:135], v10 offset:31232
  ds_read_b64_tr_b16 v[136:137], v10 offset:38912
  ds_read_b64_tr_b16 v[138:139], v10 offset:39424
  ds_read_b128 v[96:99], v7 offset:2048
  ds_read_b128 v[100:103], v7 offset:4096
  ds_read_b128 v[104:107], v7 offset:6144
  ds_read_b128 v[108:111], v7 offset:8192
  s_waitcnt lgkmcnt(10)
  v_mfma_f32_16x16x32_bf16 v[16:19], v[116:119], v[76:79], v[16:19]
  v_mfma_f32_16x16x32_bf16 v[20:23], v[116:119], v[80:83], v[20:23]
  v_mfma_f32_16x16x32_bf16 v[24:27], v[116:119], v[84:87], v[24:27]
  v_mfma_f32_16x16x32_bf16 v[28:31], v[116:119], v[88:91], v[28:31]
  v_mfma_f32_16x16x32_bf16 v[36:39], v[120:123], v[76:79], v[36:39]
  v_mfma_f32_16x16x32_bf16 v[40:43], v[120:123], v[80:83], v[40:43]
  v_mfma_f32_16x16x32_bf16 v[44:47], v[120:123], v[84:87], v[44:47]
  v_mfma_f32_16x16x32_bf16 v[48:51], v[120:123], v[88:91], v[48:51]
  v_mfma_f32_16x16x32_bf16 v[56:59], v[124:127], v[76:79], v[56:59]
  v_mfma_f32_16x16x32_bf16 v[60:63], v[124:127], v[80:83], v[60:63]
  v_mfma_f32_16x16x32_bf16 v[64:67], v[124:127], v[84:87], v[64:67]
  v_mfma_f32_16x16x32_bf16 v[68:71], v[124:127], v[88:91], v[68:71]
  s_cmp_eq_u32 s31, 0
  s_cbranch_scc1 k1m_3
  v_mfma_f32_16x16x32_bf16 v[52:55], v[120:123], v[92:95], v[52:55]
  v_mfma_f32_16x16x32_bf16 v[72:75], v[124:127], v[92:95], v[72:75]
k1m_3:
  s_waitcnt lgkmcnt(0)
  s_barrier
  s_cmp_eq_u32 s31, 0
  s_cbranch_scc1 k1x_4
  ds_read_b128 v[92:95], v5 offset:0
k1x_4:
  ds_read_b64_tr_b16 v[116:117], v11 offset:18432
  ds_read_b64_tr_b16 v[118:119], v11 offset:18944
  ds_read_b64_tr_b16 v[120:121], v11 offset:26624
  ds_read_b64_tr_b16 v[122:123], v11 offset:27136
  ds_read_b64_tr_b16 v[124:125], v11 offset:34816
  ds_read_b64_tr_b16 v[126:127], v11 offset:35328
  ds_read_b128 v[76:79], v5 offset:2048
  ds_read_b128 v[80:83], v5 offset:4096
  ds_read_b128 v[84:87], v5 offset:6144
  ds_read_b128 v[88:91], v5 offset:8192
  v_mfma_f32_16x16x32_bf16 v[16:19], v[128:131], v[96:99], v[16:19]
  v_mfma_f32_16x16x32_bf16 v[20:23], v[128:131], v[100:103], v[20:23]
  v_mfma_f32_16x16x32_bf16 v[24:27], v[128:131], v[104:107], v[24:27]
  v_mfma_f32_16x16x32_bf16 v[28:31], v[128:131], v[108:111], v[28:31]
  v_mfma_f32_16x16x32_bf16 v[36:39], v[132:135], v[96:99], v[36:39]
  v_mfma_f32_16x16x32_bf16 v[40:43], v[132:135], v[100:103], v[40:43]
  v_mfma_f32_16x16x32_bf16 v[44:47], v[132:135], v[104:107], v[44:47]
  v_mfma_f32_16x16x32_bf16 v[48:51], v[132:135], v[108:111], v[48:51]
  v_mfma_f32_16x16x32_bf16 v[56:59], v[136:139], v[96:99], v[56:59]
  v_mfma_f32_16x16x32_bf16 v[60:63], v[136:139], v[100:103], v[60:63]
  v_mfma_f32_16x16x32_bf16 v[64:67], v[136:139], v[104:107], v[64:67]
  v_mfma_f32_16x16x32_bf16 v[68:71], v[136:139], v[108:111], v[68:71]
  s_cmp_eq_u32 s31, 0
  s_cbranch_scc1 k1m_5
  v_mfma_f32_16x16x32_bf16 v[52:55], v[132:135], v[112:115], v[52:55]
  v_mfma_f32_16x16x32_bf16 v[72:75], v[136:139], v[112:115], v[72:75]
k1m_5:
  s_mov_b32 s84, s78
  s_and_b32 s85, s79, 0xffff
  s_mov_b32 s86, 8388608
  s_mov_b32 s87, 0x00020000
  s_add_u32 s48, s75, 1048576
  buffer_load_dwordx4 v[164:167], v160, s[84:87], s48 offen
  s_cmp_eq_u32 s31, 0
  s_cbranch_scc1 k1x_6
  ds_read_b128 v[112:115], v8 offset:0
k1x_6:
  ds_read_b64_tr_b16 v[128:129], v11 offset:22528
  ds_read_b64_tr_b16 v[130:131], v11 offset:23040
  ds_read_b64_tr_b16 v[132:133], v11 offset:30720
  ds_read_b64_tr_b16 v[134:135], v11 offset:31232
  ds_read_b64_tr_b16 v[136:137], v11 offset:38912
  ds_read_b64_tr_b16 v[138:139], v11 offset:39424
  ds_read_b128 v[96:99], v8 offset:2048
  ds_read_b128 v[100:103], v8 offset:4096
  ds_read_b128 v[104:107], v8 offset:6144
  ds_read_b128 v[108:111], v8 offset:8192
  s_waitcnt lgkmcnt(10)
  v_mfma_f32_16x16x32_bf16 v[16:19], v[116:119], v[76:79], v[16:19]
  v_mfma_f32_16x16x32_bf16 v[20:23], v[116:119], v[80:83], v[20:23]
  v_mfma_f32_16x16x32_bf16 v[24:27], v[116:119], v[84:87], v[24:27]
  v_mfma_f32_16x16x32_bf16 v[28:31], v[116:119], v[88:91], v[28:31]
  v_mfma_f32_16x16x32_bf16 v[36:39], v[120:123], v[76:79], v[36:39]
  v_mfma_f32_16x16x32_bf16 v[40:43], v[120:123], v[80:83], v[40:43]
  v_mfma_f32_16x16x32_bf16 v[44:47], v[120:123], v[84:87], v[44:47]
  v_mfma_f32_16x16x32_bf16 v[48:51], v[120:123], v[88:91], v[48:51]
  v_mfma_f32_16x16x32_bf16 v[56:59], v[124:127], v[76:79], v[56:59]
  v_mfma_f32_16x16x32_bf16 v[60:63], v[124:127], v[80:83], v[60:63]
  v_mfma_f32_16x16x32_bf16 v[64:67], v[124:127], v[84:87], v[64:67]
  v_mfma_f32_16x16x32_bf16 v[68:71], v[124:127], v[88:91], v[68:71]
  s_cmp_eq_u32 s31, 0
  s_cbranch_scc1 k1m_7
  v_mfma_f32_16x16x32_bf16 v[52:55], v[120:123], v[92:95], v[52:55]
  v_mfma_f32_16x16x32_bf16 v[72:75], v[124:127], v[92:95], v[72:75]
k1m_7:
  s_waitcnt lgkmcnt(0)
  s_barrier
  s_cmp_eq_u32 s31, 0
  s_cbranch_scc1 k1x_8
  ds_read_b128 v[92:95], v6 offset:0
k1x_8:
  ds_read_b64_tr_b16 v[116:117], v12 offset:18432
  ds_read_b64_tr_b16 v[118:119], v12 offset:18944
  ds_read_b64_tr_b16 v[120:121], v12 offset:26624
  ds_read_b64_tr_b16 v[122:123], v12 offset:27136
  ds_read_b64_tr_b16 v[124:125], v12 offset:34816
  ds_read_b64_tr_b16 v[126:127], v12 offset:35328
  ds_read_b128 v[76:79], v6 offset:2048
  ds_read_b128 v[80:83], v6 offset:4096
  ds_read_b128 v[84:87], v6 offset:6144
  ds_read_b128 v[88:91], v6 offset:8192
  v_mfma_f32_16x16x32_bf16 v[16:19], v[128:131], v[96:99], v[16:19]
  v_mfma_f32_16x16x32_bf16 v[20:23], v[128:131], v[100:103], v[20:23]
  v_mfma_f32_16x16x32_bf16 v[24:27], v[128:131], v[104:107], v[24:27]
  v_mfma_f32_16x16x32_bf16 v[28:31], v[128:131], v[108:111], v[28:31]
  v_mfma_f32_16x16x32_bf16 v[36:39], v[132:135], v[96:99], v[36:39]
  v_mfma_f32_16x16x32_bf16 v[40:43], v[132:135], v[100:103], v[40:43]
  v_mfma_f32_16x16x32_bf16 v[44:47], v[132:135], v[104:107], v[44:47]
  v_mfma_f32_16x16x32_bf16 v[48:51], v[132:135], v[108:111], v[48:51]
  v_mfma_f32_16x16x32_bf16 v[56:59], v[136:139], v[96:99], v[56:59]
  v_mfma_f32_16x16x32_bf16 v[60:63], v[136:139], v[100:103], v[60:63]
  v_mfma_f32_16x16x32_bf16 v[64:67], v[136:139], v[104:107], v[64:67]
  v_mfma_f32_16x16x32_bf16 v[68:71], v[136:139], v[108:111], v[68:71]
  s_cmp_eq_u32 s31, 0
  s_cbranch_scc1 k1m_9
  v_mfma_f32_16x16x32_bf16 v[52:55], v[132:135], v[112:115], v[52:55]
  v_mfma_f32_16x16x32_bf16 v[72:75], v[136:139], v[112:115], v[72:75]
k1m_9:
  s_mov_b32 s84, s78
  s_and_b32 s85, s79, 0xffff
  s_mov_b32 s86, 8388608
  s_mov_b32 s87, 0x00020000
  s_add_u32 s48, s75, 2097152
  buffer_load_dwordx4 v[164:167], v160, s[84:87], s48 offen
  s_cmp_eq_u32 s31, 0
  s_cbranch_scc1 k1x_10
  ds_read_b128 v[112:115], v9 offset:0
k1x_10:
  ds_read_b64_tr_b16 v[128:129], v12 offset:22528
  ds_read_b64_tr_b16 v[130:131], v12 offset:23040
  ds_read_b64_tr_b16 v[132:133], v12 offset:30720
  ds_read_b64_tr_b16 v[134:135], v12 offset:31232
  ds_read_b64_tr_b16 v[136:137], v12 offset:38912
  ds_read_b64_tr_b16 v[138:139], v12 offset:39424
  ds_read_b128 v[96:99], v9 offset:2048
  ds_read_b128 v[100:103], v9 offset:4096
  ds_read_b128 v[104:107], v9 offset:6144
  ds_read_b128 v[108:111], v9 offset:8192
  s_waitcnt lgkmcnt(10)
  v_mfma_f32_16x16x32_bf16 v[16:19], v[116:119], v[76:79], v[16:19]
  v_mfma_f32_16x16x32_bf16 v[20:23], v[116:119], v[80:83], v[20:23]
  v_mfma_f32_16x16x32_bf16 v[24:27], v[116:119], v[84:87], v[24:27]
  v_mfma_f32_16x16x32_bf16 v[28:31], v[116:119], v[88:91], v[28:31]
  v_mfma_f32_16x16x32_bf16 v[36:39], v[120:123], v[76:79], v[36:39]
  v_mfma_f32_16x16x32_bf16 v[40:43], v[120:123], v[80:83], v[40:43]
  v_mfma_f32_16x16x32_bf16 v[44:47], v[120:123], v[84:87], v[44:47]
  v_mfma_f32_16x16x32_bf16 v[48:51], v[120:123], v[88:91], v[48:51]
  v_mfma_f32_16x16x32_bf16 v[56:59], v[124:127], v[76:79], v[56:59]
  v_mfma_f32_16x16x32_bf16 v[60:63], v[124:127], v[80:83], v[60:63]
  v_mfma_f32_16x16x32_bf16 v[64:67], v[124:127], v[84:87], v[64:67]
  v_mfma_f32_16x16x32_bf16 v[68:71], v[124:127], v[88:91], v[68:71]
  s_cmp_eq_u32 s31, 0
  s_cbranch_scc1 k1m_11
  v_mfma_f32_16x16x32_bf16 v[52:55], v[120:123], v[92:95], v[52:55]
  v_mfma_f32_16x16x32_bf16 v[72:75], v[124:127], v[92:95], v[72:75]
k1m_11:
  s_waitcnt lgkmcnt(0)
  s_barrier
  s_cmp_eq_u32 s31, 0
  s_cbranch_scc1 k1x_12
  ds_read_b128 v[92:95], v4 offset:0
k1x_12:
  ds_read_b64_tr_b16 v[116:117], v10 offset:18432
  ds_read_b64_tr_b16 v[118:119], v10 offset:18944
  ds_read_b64_tr_b16 v[120:121], v10 offset:26624
  ds_read_b64_tr_b16 v[122:123], v10 offset:27136
  ds_read_b64_tr_b16 v[124:125], v10 offset:34816
  ds_read_b64_tr_b16 v[126:127], v10 offset:35328
  ds_read_b128 v[76:79], v4 offset:2048
  ds_read_b128 v[80:83], v4 offset:4096
  ds_read_b128 v[84:87], v4 offset:6144
  ds_read_b128 v[88:91], v4 offset:8192
  v_mfma_f32_16x16x32_bf16 v[16:19], v[128:131], v[96:99], v[16:19]
  v_mfma_f32_16x16x32_bf16 v[20:23], v[128:131], v[100:103], v[20:23]
  v_mfma_f32_16x16x32_bf16 v[24:27], v[128:131], v[104:107], v[24:27]
  v_mfma_f32_16x16x32_bf16 v[28:31], v[128:131], v[108:111], v[28:31]
  v_mfma_f32_16x16x32_bf16 v[36:39], v[132:135], v[96:99], v[36:39]
  v_mfma_f32_16x16x32_bf16 v[40:43], v[132:135], v[100:103], v[40:43]
  v_mfma_f32_16x16x32_bf16 v[44:47], v[132:135], v[104:107], v[44:47]
  v_mfma_f32_16x16x32_bf16 v[48:51], v[132:135], v[108:111], v[48:51]
  v_mfma_f32_16x16x32_bf16 v[56:59], v[136:139], v[96:99], v[56:59]
  v_mfma_f32_16x16x32_bf16 v[60:63], v[136:139], v[100:103], v[60:63]
  v_mfma_f32_16x16x32_bf16 v[64:67], v[136:139], v[104:107], v[64:67]
  v_mfma_f32_16x16x32_bf16 v[68:71], v[136:139], v[108:111], v[68:71]
  s_cmp_eq_u32 s31, 0
  s_cbranch_scc1 k1m_13
  v_mfma_f32_16x16x32_bf16 v[52:55], v[132:135], v[112:115], v[52:55]
  v_mfma_f32_16x16x32_bf16 v[72:75], v[136:139], v[112:115], v[72:75]
k1m_13:
  s_mov_b32 s84, s78
  s_and_b32 s85, s79, 0xffff
  s_mov_b32 s86, 8388608
  s_mov_b32 s87, 0x00020000
  s_add_u32 s48, s75, 3145728
  buffer_load_dwordx4 v[164:167], v160, s[84:87], s48 offen
  s_cmp_eq_u32 s31, 0
  s_cbranch_scc1 k1x_14
  ds_read_b128 v[112:115], v7 offset:0
k1x_14:
  ds_read_b64_tr_b16 v[128:129], v10 offset:22528
  ds_read_b64_tr_b16 v[130:131], v10 offset:23040
  ds_read_b64_tr_b16 v[132:133], v10 offset:30720
  ds_read_b64_tr_b16 v[134:135], v10 offset:31232
  ds_read_b64_tr_b16 v[136:137], v10 offset:38912
  ds_read_b64_tr_b16 v[138:139], v10 offset:39424
  ds_read_b128 v[96:99], v7 offset:2048
  ds_read_b128 v[100:103], v7 offset:4096
  ds_read_b128 v[104:107], v7 offset:6144
  ds_read_b128 v[108:111], v7 offset:8192
  s_waitcnt lgkmcnt(10)
  v_mfma_f32_16x16x32_bf16 v[16:19], v[116:119], v[76:79], v[16:19]
  v_mfma_f32_16x16x32_bf16 v[20:23], v[116:119], v[80:83], v[20:23]
  v_mfma_f32_16x16x32_bf16 v[24:27], v[116:119], v[84:87], v[24:27]
  v_mfma_f32_16x16x32_bf16 v[28:31], v[116:119], v[88:91], v[28:31]
  v_mfma_f32_16x16x32_bf16 v[36:39], v[120:123], v[76:79], v[36:39]
  v_mfma_f32_16x16x32_bf16 v[40:43], v[120:123], v[80:83], v[40:43]
  v_mfma_f32_16x16x32_bf16 v[44:47], v[120:123], v[84:87], v[44:47]
  v_mfma_f32_16x16x32_bf16 v[48:51], v[120:123], v[88:91], v[48:51]
  v_mfma_f32_16x16x32_bf16 v[56:59], v[124:127], v[76:79], v[56:59]
  v_mfma_f32_16x16x32_bf16 v[60:63], v[124:127], v[80:83], v[60:63]
  v_mfma_f32_16x16x32_bf16 v[64:67], v[124:127], v[84:87], v[64:67]
  v_mfma_f32_16x16x32_bf16 v[68:71], v[124:127], v[88:91], v[68:71]
  s_cmp_eq_u32 s31, 0
  s_cbranch_scc1 k1m_15
  v_mfma_f32_16x16x32_bf16 v[52:55], v[120:123], v[92:95], v[52:55]
  v_mfma_f32_16x16x32_bf16 v[72:75], v[124:127], v[92:95], v[72:75]
k1m_15:
  s_waitcnt lgkmcnt(0)
  s_barrier
  s_cmp_eq_u32 s31, 0
  s_cbranch_scc1 k1x_16
  ds_read_b128 v[92:95], v5 offset:0
k1x_16:
  ds_read_b64_tr_b16 v[116:117], v11 offset:18432
  ds_read_b64_tr_b16 v[118:119], v11 offset:18944
  ds_read_b64_tr_b16 v[120:121], v11 offset:26624
  ds_read_b64_tr_b16 v[122:123], v11 offset:27136
  ds_read_b64_tr_b16 v[124:125], v11 offset:34816
  ds_read_b64_tr_b16 v[126:127], v11 offset:35328
  ds_read_b128 v[76:79], v5 offset:2048
  ds_read_b128 v[80:83], v5 offset:4096
  ds_read_b128 v[84:87], v5 offset:6144
  ds_read_b128 v[88:91], v5 offset:8192
  v_mfma_f32_16x16x32_bf16 v[16:19], v[128:131], v[96:99], v[16:19]
  v_mfma_f32_16x16x32_bf16 v[20:23], v[128:131], v[100:103], v[20:23]
  v_mfma_f32_16x16x32_bf16 v[24:27], v[128:131], v[104:107], v[24:27]
  v_mfma_f32_16x16x32_bf16 v[28:31], v[128:131], v[108:111], v[28:31]
  v_mfma_f32_16x16x32_bf16 v[36:39], v[132:135], v[96:99], v[36:39]
  v_mfma_f32_16x16x32_bf16 v[40:43], v[132:135], v[100:103], v[40:43]
  v_mfma_f32_16x16x32_bf16 v[44:47], v[132:135], v[104:107], v[44:47]
  v_mfma_f32_16x16x32_bf16 v[48:51], v[132:135], v[108:111], v[48:51]
  v_mfma_f32_16x16x32_bf16 v[56:59], v[136:139], v[96:99], v[56:59]
  v_mfma_f32_16x16x32_bf16 v[60:63], v[136:139], v[100:103], v[60:63]
  v_mfma_f32_16x16x32_bf16 v[64:67], v[136:139], v[104:107], v[64:67]
  v_mfma_f32_16x16x32_bf16 v[68:71], v[136:139], v[108:111], v[68:71]
  s_cmp_eq_u32 s31, 0
  s_cbranch_scc1 k1m_17
  v_mfma_f32_16x16x32_bf16 v[52:55], v[132:135], v[112:115], v[52:55]
  v_mfma_f32_16x16x32_bf16 v[72:75], v[136:139], v[112:115], v[72:75]
k1m_17:
  s_mov_b32 s84, s78
  s_and_b32 s85, s79, 0xffff
  s_mov_b32 s86, 8388608
  s_mov_b32 s87, 0x00020000
  s_add_u32 s48, s75, 4194304
  buffer_load_dwordx4 v[164:167], v160, s[84:87], s48 offen
  s_cmp_eq_u32 s31, 0
  s_cbranch_scc1 k1x_18
  ds_read_b128 v[112:115], v8 offset:0
k1x_18:
  ds_read_b64_tr_b16 v[128:129], v11 offset:22528
  ds_read_b64_tr_b16 v[130:131], v11 offset:23040
  ds_read_b64_tr_b16 v[132:133], v11 offset:30720
  ds_read_b64_tr_b16 v[134:135], v11 offset:31232
  ds_read_b64_tr_b16 v[136:137], v11 offset:38912
  ds_read_b64_tr_b16 v[138:139], v11 offset:39424
  ds_read_b128 v[96:99], v8 offset:2048
  ds_read_b128 v[100:103], v8 offset:4096
  ds_read_b128 v[104:107], v8 offset:6144
  ds_read_b128 v[108:111], v8 offset:8192
  s_waitcnt lgkmcnt(10)
  v_mfma_f32_16x16x32_bf16 v[16:19], v[116:119], v[76:79], v[16:19]
  v_mfma_f32_16x16x32_bf16 v[20:23], v[116:119], v[80:83], v[20:23]
  v_mfma_f32_16x16x32_bf16 v[24:27], v[116:119], v[84:87], v[24:27]
  v_mfma_f32_16x16x32_bf16 v[28:31], v[116:119], v[88:91], v[28:31]
  v_mfma_f32_16x16x32_bf16 v[36:39], v[120:123], v[76:79], v[36:39]
  v_mfma_f32_16x16x32_bf16 v[40:43], v[120:123], v[80:83], v[40:43]
  v_mfma_f32_16x16x32_bf16 v[44:47], v[120:123], v[84:87], v[44:47]
  v_mfma_f32_16x16x32_bf16 v[48:51], v[120:123], v[88:91], v[48:51]
  v_mfma_f32_16x16x32_bf16 v[56:59], v[124:127], v[76:79], v[56:59]
  v_mfma_f32_16x16x32_bf16 v[60:63], v[124:127], v[80:83], v[60:63]
  v_mfma_f32_16x16x32_bf16 v[64:67], v[124:127], v[84:87], v[64:67]
  v_mfma_f32_16x16x32_bf16 v[68:71], v[124:127], v[88:91], v[68:71]
  s_cmp_eq_u32 s31, 0
  s_cbranch_scc1 k1m_19
  v_mfma_f32_16x16x32_bf16 v[52:55], v[120:123], v[92:95], v[52:55]
  v_mfma_f32_16x16x32_bf16 v[72:75], v[124:127], v[92:95], v[72:75]
k1m_19:
  s_waitcnt lgkmcnt(0)
  s_barrier
  s_cmp_eq_u32 s31, 0
  s_cbranch_scc1 k1x_20
  ds_read_b128 v[92:95], v6 offset:0
k1x_20:
  ds_read_b64_tr_b16 v[116:117], v12 offset:18432
  ds_read_b64_tr_b16 v[118:119], v12 offset:18944
  ds_read_b64_tr_b16 v[120:121], v12 offset:26624
  ds_read_b64_tr_b16 v[122:123], v12 offset:27136
  ds_read_b64_tr_b16 v[124:125], v12 offset:34816
  ds_read_b64_tr_b16 v[126:127], v12 offset:35328
  ds_read_b128 v[76:79], v6 offset:2048
  ds_read_b128 v[80:83], v6 offset:4096
  ds_read_b128 v[84:87], v6 offset:6144
  ds_read_b128 v[88:91], v6 offset:8192
  v_mfma_f32_16x16x32_bf16 v[16:19], v[128:131], v[96:99], v[16:19]
  v_mfma_f32_16x16x32_bf16 v[20:23], v[128:131], v[100:103], v[20:23]
  v_mfma_f32_16x16x32_bf16 v[24:27], v[128:131], v[104:107], v[24:27]
  v_mfma_f32_16x16x32_bf16 v[28:31], v[128:131], v[108:111], v[28:31]
  v_mfma_f32_16x16x32_bf16 v[36:39], v[132:135], v[96:99], v[36:39]
  v_mfma_f32_16x16x32_bf16 v[40:43], v[132:135], v[100:103], v[40:43]
  v_mfma_f32_16x16x32_bf16 v[44:47], v[132:135], v[104:107], v[44:47]
  v_mfma_f32_16x16x32_bf16 v[48:51], v[132:135], v[108:111], v[48:51]
  v_mfma_f32_16x16x32_bf16 v[56:59], v[136:139], v[96:99], v[56:59]
  v_mfma_f32_16x16x32_bf16 v[60:63], v[136:139], v[100:103], v[60:63]
  v_mfma_f32_16x16x32_bf16 v[64:67], v[136:139], v[104:107], v[64:67]
  v_mfma_f32_16x16x32_bf16 v[68:71], v[136:139], v[108:111], v[68:71]
  s_cmp_eq_u32 s31, 0
  s_cbranch_scc1 k1m_21
  v_mfma_f32_16x16x32_bf16 v[52:55], v[132:135], v[112:115], v[52:55]
  v_mfma_f32_16x16x32_bf16 v[72:75], v[136:139], v[112:115], v[72:75]
k1m_21:
  s_mov_b32 s84, s78
  s_and_b32 s85, s79, 0xffff
  s_mov_b32 s86, 8388608
  s_mov_b32 s87, 0x00020000
  s_add_u32 s48, s75, 5242880
  buffer_load_dwordx4 v[164:167], v160, s[84:87], s48 offen
  s_cmp_eq_u32 s31, 0
  s_cbranch_scc1 k1x_22
  ds_read_b128 v[112:115], v9 offset:0
k1x_22:
  ds_read_b64_tr_b16 v[128:129], v12 offset:22528
  ds_read_b64_tr_b16 v[130:131], v12 offset:23040
  ds_read_b64_tr_b16 v[132:133], v12 offset:30720
  ds_read_b64_tr_b16 v[134:135], v12 offset:31232
  ds_read_b64_tr_b16 v[136:137], v12 offset:38912
  ds_read_b64_tr_b16 v[138:139], v12 offset:39424
  ds_read_b128 v[96:99], v9 offset:2048
  ds_read_b128 v[100:103], v9 offset:4096
  ds_read_b128 v[104:107], v9 offset:6144
  ds_read_b128 v[108:111], v9 offset:8192
  s_waitcnt lgkmcnt(10)
  v_mfma_f32_16x16x32_bf16 v[16:19], v[116:119], v[76:79], v[16:19]
  v_mfma_f32_16x16x32_bf16 v[20:23], v[116:119], v[80:83], v[20:23]
  v_mfma_f32_16x16x32_bf16 v[24:27], v[116:119], v[84:87], v[24:27]
  v_mfma_f32_16x16x32_bf16 v[28:31], v[116:119], v[88:91], v[28:31]
  v_mfma_f32_16x16x32_bf16 v[36:39], v[120:123], v[76:79], v[36:39]
  v_mfma_f32_16x16x32_bf16 v[40:43], v[120:123], v[80:83], v[40:43]
  v_mfma_f32_16x16x32_bf16 v[44:47], v[120:123], v[84:87], v[44:47]
  v_mfma_f32_16x16x32_bf16 v[48:51], v[120:123], v[88:91], v[48:51]
  v_mfma_f32_16x16x32_bf16 v[56:59], v[124:127], v[76:79], v[56:59]
  v_mfma_f32_16x16x32_bf16 v[60:63], v[124:127], v[80:83], v[60:63]
  v_mfma_f32_16x16x32_bf16 v[64:67], v[124:127], v[84:87], v[64:67]
  v_mfma_f32_16x16x32_bf16 v[68:71], v[124:127], v[88:91], v[68:71]
  s_cmp_eq_u32 s31, 0
  s_cbranch_scc1 k1m_23
  v_mfma_f32_16x16x32_bf16 v[52:55], v[120:123], v[92:95], v[52:55]
  v_mfma_f32_16x16x32_bf16 v[72:75], v[124:127], v[92:95], v[72:75]
k1m_23:
  s_waitcnt lgkmcnt(0)
  s_barrier
  s_cmp_eq_u32 s31, 0
  s_cbranch_scc1 k1x_24
  ds_read_b128 v[92:95], v4 offset:0
k1x_24:
  ds_read_b64_tr_b16 v[116:117], v10 offset:18432
  ds_read_b64_tr_b16 v[118:119], v10 offset:18944
  ds_read_b64_tr_b16 v[120:121], v10 offset:26624
  ds_read_b64_tr_b16 v[122:123], v10 offset:27136
  ds_read_b64_tr_b16 v[124:125], v10 offset:34816
  ds_read_b64_tr_b16 v[126:127], v10 offset:35328
  ds_read_b128 v[76:79], v4 offset:2048
  ds_read_b128 v[80:83], v4 offset:4096
  ds_read_b128 v[84:87], v4 offset:6144
  ds_read_b128 v[88:91], v4 offset:8192
  v_mfma_f32_16x16x32_bf16 v[16:19], v[128:131], v[96:99], v[16:19]
  v_mfma_f32_16x16x32_bf16 v[20:23], v[128:131], v[100:103], v[20:23]
  v_mfma_f32_16x16x32_bf16 v[24:27], v[128:131], v[104:107], v[24:27]
  v_mfma_f32_16x16x32_bf16 v[28:31], v[128:131], v[108:111], v[28:31]
  v_mfma_f32_16x16x32_bf16 v[36:39], v[132:135], v[96:99], v[36:39]
  v_mfma_f32_16x16x32_bf16 v[40:43], v[132:135], v[100:103], v[40:43]
  v_mfma_f32_16x16x32_bf16 v[44:47], v[132:135], v[104:107], v[44:47]
  v_mfma_f32_16x16x32_bf16 v[48:51], v[132:135], v[108:111], v[48:51]
  v_mfma_f32_16x16x32_bf16 v[56:59], v[136:139], v[96:99], v[56:59]
  v_mfma_f32_16x16x32_bf16 v[60:63], v[136:139], v[100:103], v[60:63]
  v_mfma_f32_16x16x32_bf16 v[64:67], v[136:139], v[104:107], v[64:67]
  v_mfma_f32_16x16x32_bf16 v[68:71], v[136:139], v[108:111], v[68:71]
  s_cmp_eq_u32 s31, 0
  s_cbranch_scc1 k1m_25
  v_mfma_f32_16x16x32_bf16 v[52:55], v[132:135], v[112:115], v[52:55]
  v_mfma_f32_16x16x32_bf16 v[72:75], v[136:139], v[112:115], v[72:75]
k1m_25:
  s_mov_b32 s84, s78
  s_and_b32 s85, s79, 0xffff
  s_mov_b32 s86, 8388608
  s_mov_b32 s87, 0x00020000
  s_add_u32 s48, s75, 6291456
  buffer_load_dwordx4 v[164:167], v160, s[84:87], s48 offen
  s_mov_b32 s84, s76
  s_and_b32 s85, s77, 0xffff
  s_mov_b32 s86, 524288
  s_mov_b32 s87, 0x00020000
  buffer_load_dwordx4 v[164:167], v160, s[84:87], s75 offen
  s_cmp_eq_u32 s31, 0
  s_cbranch_scc1 k1x_26
  ds_read_b128 v[112:115], v7 offset:0
k1x_26:
  ds_read_b64_tr_b16 v[128:129], v10 offset:22528
  ds_read_b64_tr_b16 v[130:131], v10 offset:23040
  ds_read_b64_tr_b16 v[132:133], v10 offset:30720
  ds_read_b64_tr_b16 v[134:135], v10 offset:31232
  ds_read_b64_tr_b16 v[136:137], v10 offset:38912
  ds_read_b64_tr_b16 v[138:139], v10 offset:39424
  ds_read_b128 v[96:99], v7 offset:2048
  ds_read_b128 v[100:103], v7 offset:4096
  ds_read_b128 v[104:107], v7 offset:6144
  ds_read_b128 v[108:111], v7 offset:8192
  s_waitcnt lgkmcnt(10)
  v_mfma_f32_16x16x32_bf16 v[16:19], v[116:119], v[76:79], v[16:19]
  v_mfma_f32_16x16x32_bf16 v[20:23], v[116:119], v[80:83], v[20:23]
  v_mfma_f32_16x16x32_bf16 v[24:27], v[116:119], v[84:87], v[24:27]
  v_mfma_f32_16x16x32_bf16 v[28:31], v[116:119], v[88:91], v[28:31]
  v_mfma_f32_16x16x32_bf16 v[36:39], v[120:123], v[76:79], v[36:39]
  v_mfma_f32_16x16x32_bf16 v[40:43], v[120:123], v[80:83], v[40:43]
  v_mfma_f32_16x16x32_bf16 v[44:47], v[120:123], v[84:87], v[44:47]
  v_mfma_f32_16x16x32_bf16 v[48:51], v[120:123], v[88:91], v[48:51]
  v_mfma_f32_16x16x32_bf16 v[56:59], v[124:127], v[76:79], v[56:59]
  v_mfma_f32_16x16x32_bf16 v[60:63], v[124:127], v[80:83], v[60:63]
  v_mfma_f32_16x16x32_bf16 v[64:67], v[124:127], v[84:87], v[64:67]
  v_mfma_f32_16x16x32_bf16 v[68:71], v[124:127], v[88:91], v[68:71]
  s_cmp_eq_u32 s31, 0
  s_cbranch_scc1 k1m_27
  v_mfma_f32_16x16x32_bf16 v[52:55], v[120:123], v[92:95], v[52:55]
  v_mfma_f32_16x16x32_bf16 v[72:75], v[124:127], v[92:95], v[72:75]
k1m_27:
  s_waitcnt lgkmcnt(0)
  s_barrier
  s_cmp_eq_u32 s31, 0
  s_cbranch_scc1 k1x_28
  ds_read_b128 v[92:95], v5 offset:0
k1x_28:
  ds_read_b64_tr_b16 v[116:117], v11 offset:18432
  ds_read_b64_tr_b16 v[118:119], v11 offset:18944
  ds_read_b64_tr_b16 v[120:121], v11 offset:26624
  ds_read_b64_tr_b16 v[122:123], v11 offset:27136
  ds_read_b64_tr_b16 v[124:125], v11 offset:34816
  ds_read_b64_tr_b16 v[126:127], v11 offset:35328
  ds_read_b128 v[76:79], v5 offset:2048
  ds_read_b128 v[80:83], v5 offset:4096
  ds_read_b128 v[84:87], v5 offset:6144
  ds_read_b128 v[88:91], v5 offset:8192
  v_mfma_f32_16x16x32_bf16 v[16:19], v[128:131], v[96:99], v[16:19]
  v_mfma_f32_16x16x32_bf16 v[20:23], v[128:131], v[100:103], v[20:23]
  v_mfma_f32_16x16x32_bf16 v[24:27], v[128:131], v[104:107], v[24:27]
  v_mfma_f32_16x16x32_bf16 v[28:31], v[128:131], v[108:111], v[28:31]
  v_mfma_f32_16x16x32_bf16 v[36:39], v[132:135], v[96:99], v[36:39]
  v_mfma_f32_16x16x32_bf16 v[40:43], v[132:135], v[100:103], v[40:43]
  v_mfma_f32_16x16x32_bf16 v[44:47], v[132:135], v[104:107], v[44:47]
  v_mfma_f32_16x16x32_bf16 v[48:51], v[132:135], v[108:111], v[48:51]
  v_mfma_f32_16x16x32_bf16 v[56:59], v[136:139], v[96:99], v[56:59]
  v_mfma_f32_16x16x32_bf16 v[60:63], v[136:139], v[100:103], v[60:63]
  v_mfma_f32_16x16x32_bf16 v[64:67], v[136:139], v[104:107], v[64:67]
  v_mfma_f32_16x16x32_bf16 v[68:71], v[136:139], v[108:111], v[68:71]
  s_cmp_eq_u32 s31, 0
  s_cbranch_scc1 k1m_29
  v_mfma_f32_16x16x32_bf16 v[52:55], v[132:135], v[112:115], v[52:55]
  v_mfma_f32_16x16x32_bf16 v[72:75], v[136:139], v[112:115], v[72:75]
k1m_29:
  s_mov_b32 s84, s78
  s_and_b32 s85, s79, 0xffff
  s_mov_b32 s86, 8388608
  s_mov_b32 s87, 0x00020000
  s_add_u32 s48, s75, 7340032
  buffer_load_dwordx4 v[164:167], v160, s[84:87], s48 offen
  s_mov_b32 s84, s80
  s_and_b32 s85, s81, 0xffff
  s_mov_b32 s86, 704512
  s_mov_b32 s87, 0x00020000
  buffer_load_dwordx4 v[164:167], v160, s[84:87], s75 offen
  s_cmp_eq_u32 s31, 0
  s_cbranch_scc1 k1x_30
  ds_read_b128 v[112:115], v8 offset:0
k1x_30:
  ds_read_b64_tr_b16 v[128:129], v11 offset:22528
  ds_read_b64_tr_b16 v[130:131], v11 offset:23040
  ds_read_b64_tr_b16 v[132:133], v11 offset:30720
  ds_read_b64_tr_b16 v[134:135], v11 offset:31232
  ds_read_b64_tr_b16 v[136:137], v11 offset:38912
  ds_read_b64_tr_b16 v[138:139], v11 offset:39424
  ds_read_b128 v[96:99], v8 offset:2048
  ds_read_b128 v[100:103], v8 offset:4096
  ds_read_b128 v[104:107], v8 offset:6144
  ds_read_b128 v[108:111], v8 offset:8192
  s_waitcnt lgkmcnt(10)
  v_mfma_f32_16x16x32_bf16 v[16:19], v[116:119], v[76:79], v[16:19]
  v_mfma_f32_16x16x32_bf16 v[20:23], v[116:119], v[80:83], v[20:23]
  v_mfma_f32_16x16x32_bf16 v[24:27], v[116:119], v[84:87], v[24:27]
  v_mfma_f32_16x16x32_bf16 v[28:31], v[116:119], v[88:91], v[28:31]
  v_mfma_f32_16x16x32_bf16 v[36:39], v[120:123], v[76:79], v[36:39]
  v_mfma_f32_16x16x32_bf16 v[40:43], v[120:123], v[80:83], v[40:43]
  v_mfma_f32_16x16x32_bf16 v[44:47], v[120:123], v[84:87], v[44:47]
  v_mfma_f32_16x16x32_bf16 v[48:51], v[120:123], v[88:91], v[48:51]
  v_mfma_f32_16x16x32_bf16 v[56:59], v[124:127], v[76:79], v[56:59]
  v_mfma_f32_16x16x32_bf16 v[60:63], v[124:127], v[80:83], v[60:63]
  v_mfma_f32_16x16x32_bf16 v[64:67], v[124:127], v[84:87], v[64:67]
  v_mfma_f32_16x16x32_bf16 v[68:71], v[124:127], v[88:91], v[68:71]
  s_cmp_eq_u32 s31, 0
  s_cbranch_scc1 k1m_31
  v_mfma_f32_16x16x32_bf16 v[52:55], v[120:123], v[92:95], v[52:55]
  v_mfma_f32_16x16x32_bf16 v[72:75], v[124:127], v[92:95], v[72:75]
k1m_31:
  s_waitcnt lgkmcnt(0)
  v_mfma_f32_16x16x32_bf16 v[16:19], v[128:131], v[96:99], v[16:19]
  v_mfma_f32_16x16x32_bf16 v[20:23], v[128:131], v[100:103], v[20:23]
  v_mfma_f32_16x16x32_bf16 v[24:27], v[128:131], v[104:107], v[24:27]
  v_mfma_f32_16x16x32_bf16 v[28:31], v[128:131], v[108:111], v[28:31]
  v_mfma_f32_16x16x32_bf16 v[36:39], v[132:135], v[96:99], v[36:39]
  v_mfma_f32_16x16x32_bf16 v[40:43], v[132:135], v[100:103], v[40:43]
  v_mfma_f32_16x16x32_bf16 v[44:47], v[132:135], v[104:107], v[44:47]
  v_mfma_f32_16x16x32_bf16 v[48:51], v[132:135], v[108:111], v[48:51]
  v_mfma_f32_16x16x32_bf16 v[56:59], v[136:139], v[96:99], v[56:59]
  v_mfma_f32_16x16x32_bf16 v[60:63], v[136:139], v[100:103], v[60:63]
  v_mfma_f32_16x16x32_bf16 v[64:67], v[136:139], v[104:107], v[64:67]
  v_mfma_f32_16x16x32_bf16 v[68:71], v[136:139], v[108:111], v[68:71]
  s_cmp_eq_u32 s31, 0
  s_cbranch_scc1 k1m_32
  v_mfma_f32_16x16x32_bf16 v[52:55], v[132:135], v[112:115], v[52:55]
  v_mfma_f32_16x16x32_bf16 v[72:75], v[136:139], v[112:115], v[72:75]
k1m_32:
  s_nop 7
  s_nop 7
  s_barrier
  s_mul_i32 s48, s25, 13824
  v_lshrrev_b32 v2, 1, v14
  v_mul_u32_u24 v2, 2304, v2
  v_and_b32 v3, 1, v14
  v_lshl_add_u32 v2, v3, 3, v2
  v_lshl_add_u32 v2, v13, 4, v2
  s_lshl_b32 s49, s26, 10
  s_add_u32 s48, s48, s49
  v_add_u32 v2, s48, v2
  v_cvt_pk_bf16_f32 v16, v16, v17
  v_cvt_pk_bf16_f32 v17, v18, v19
  ds_write_b64 v2, v[16:17] offset:256
  v_cvt_pk_bf16_f32 v20, v20, v21
  v_cvt_pk_bf16_f32 v21, v22, v23
  ds_write_b64 v2, v[20:21] offset:512
  v_cvt_pk_bf16_f32 v24, v24, v25
  v_cvt_pk_bf16_f32 v25, v26, v27
  ds_write_b64 v2, v[24:25] offset:768
  v_cvt_pk_bf16_f32 v28, v28, v29
  v_cvt_pk_bf16_f32 v29, v30, v31
  ds_write_b64 v2, v[28:29] offset:1024
  v_cvt_pk_bf16_f32 v36, v36, v37
  v_cvt_pk_bf16_f32 v37, v38, v39
  ds_write_b64 v2, v[36:37] offset:4864
  v_cvt_pk_bf16_f32 v40, v40, v41
  v_cvt_pk_bf16_f32 v41, v42, v43
  ds_write_b64 v2, v[40:41] offset:5120
  v_cvt_pk_bf16_f32 v44, v44, v45
  v_cvt_pk_bf16_f32 v45, v46, v47
  ds_write_b64 v2, v[44:45] offset:5376
  v_cvt_pk_bf16_f32 v48, v48, v49
  v_cvt_pk_bf16_f32 v49, v50, v51
  ds_write_b64 v2, v[48:49] offset:5632
  v_cvt_pk_bf16_f32 v56, v56, v57
  v_cvt_pk_bf16_f32 v57, v58, v59
  ds_write_b64 v2, v[56:57] offset:9472
  v_cvt_pk_bf16_f32 v60, v60, v61
  v_cvt_pk_bf16_f32 v61, v62, v63
  ds_write_b64 v2, v[60:61] offset:9728
  v_cvt_pk_bf16_f32 v64, v64, v65
  v_cvt_pk_bf16_f32 v65, v66, v67
  ds_write_b64 v2, v[64:65] offset:9984
  v_cvt_pk_bf16_f32 v68, v68, v69
  v_cvt_pk_bf16_f32 v69, v70, v71
  ds_write_b64 v2, v[68:69] offset:10240
  s_cmp_eq_u32 s31, 0
  s_cbranch_scc1 k1w_33
  v_cvt_pk_bf16_f32 v52, v52, v53
  v_cvt_pk_bf16_f32 v53, v54, v55
  ds_write_b64 v2, v[52:53] offset:4608
  v_cvt_pk_bf16_f32 v72, v72, v73
  v_cvt_pk_bf16_f32 v73, v74, v75
  ds_write_b64 v2, v[72:73] offset:9216
k1w_33:
  s_waitcnt lgkmcnt(0)
  s_barrier
  s_mul_i32 s48, s25, 13824
  s_lshl_b32 s49, s26, 10
  s_add_u32 s48, s48, s49
  s_add_u32 s48, s48, 32
  v_lshlrev_b32 v2, 4, v1
  v_add_u32 v2, s48, v2
  ds_read_b128 v[16:19], v2 offset:224
  ds_read_b128 v[20:23], v2 offset:2528
  ds_read_b128 v[24:27], v2 offset:4832
  ds_read_b128 v[28:31], v2 offset:7136
  ds_read_b128 v[32:35], v2 offset:4800
  ds_read_b128 v[36:39], v2 offset:7104
  ds_read_b128 v[40:43], v2 offset:4768
  ds_read_b128 v[44:47], v2 offset:7072
  ds_read_b128 v[48:51], v2 offset:4736
  ds_read_b128 v[52:55], v2 offset:7040
  ds_read_b128 v[56:59], v2 offset:4704
  ds_read_b128 v[60:63], v2 offset:7008
  ds_read_b128 v[64:67], v2 offset:4672
  ds_read_b128 v[68:71], v2 offset:6976
  ds_read_b128 v[72:75], v2 offset:4640
  ds_read_b128 v[76:79], v2 offset:6944
  ds_read_b128 v[80:83], v2 offset:4608
  ds_read_b128 v[84:87], v2 offset:6912
  s_lshl_b32 s48, s28, 7
  s_lshl_b32 s49, s26, 6
  s_add_u32 s48, s48, s49
  v_add_u32 v3, s48, v1
  v_mov_b32 v88, 0
  v_mov_b32 v89, 0
  v_mov_b32 v90, 0
  v_mov_b32 v91, 0
  v_mov_b32 v92, 0
  v_mov_b32 v93, 0
  v_mov_b32 v94, 0
  v_mov_b32 v95, 0
  s_waitcnt lgkmcnt(0)
  v_dot2c_f32_bf16 v88, v16, v24
  v_dot2c_f32_bf16 v89, v16, v32
  v_dot2c_f32_bf16 v90, v16, v40
  v_dot2c_f32_bf16 v91, v16, v48
  v_dot2c_f32_bf16 v92, v16, v56
  v_dot2c_f32_bf16 v93, v16, v64
  v_dot2c_f32_bf16 v94, v16, v72
  v_dot2c_f32_bf16 v95, v16, v80
  v_dot2c_f32_bf16 v88, v17, v25
  v_dot2c_f32_bf16 v89, v17, v33
  v_dot2c_f32_bf16 v90, v17, v41
  v_dot2c_f32_bf16 v91, v17, v49
  v_dot2c_f32_bf16 v92, v17, v57
  v_dot2c_f32_bf16 v93, v17, v65
  v_dot2c_f32_bf16 v94, v17, v73
  v_dot2c_f32_bf16 v95, v17, v81
  v_dot2c_f32_bf16 v88, v18, v26
  v_dot2c_f32_bf16 v89, v18, v34
  v_dot2c_f32_bf16 v90, v18, v42
  v_dot2c_f32_bf16 v91, v18, v50
  v_dot2c_f32_bf16 v92, v18, v58
  v_dot2c_f32_bf16 v93, v18, v66
  v_dot2c_f32_bf16 v94, v18, v74
  v_dot2c_f32_bf16 v95, v18, v82
  v_dot2c_f32_bf16 v88, v19, v27
  v_dot2c_f32_bf16 v89, v19, v35
  v_dot2c_f32_bf16 v90, v19, v43
  v_dot2c_f32_bf16 v91, v19, v51
  v_dot2c_f32_bf16 v92, v19, v59
  v_dot2c_f32_bf16 v93, v19, v67
  v_dot2c_f32_bf16 v94, v19, v75
  v_dot2c_f32_bf16 v95, v19, v83
  v_dot2c_f32_bf16 v88, v20, v28
  v_dot2c_f32_bf16 v89, v20, v36
  v_dot2c_f32_bf16 v90, v20, v44
  v_dot2c_f32_bf16 v91, v20, v52
  v_dot2c_f32_bf16 v92, v20, v60
  v_dot2c_f32_bf16 v93, v20, v68
  v_dot2c_f32_bf16 v94, v20, v76
  v_dot2c_f32_bf16 v95, v20, v84
  v_dot2c_f32_bf16 v88, v21, v29
  v_dot2c_f32_bf16 v89, v21, v37
  v_dot2c_f32_bf16 v90, v21, v45
  v_dot2c_f32_bf16 v91, v21, v53
  v_dot2c_f32_bf16 v92, v21, v61
  v_dot2c_f32_bf16 v93, v21, v69
  v_dot2c_f32_bf16 v94, v21, v77
  v_dot2c_f32_bf16 v95, v21, v85
  v_dot2c_f32_bf16 v88, v22, v30
  v_dot2c_f32_bf16 v89, v22, v38
  v_dot2c_f32_bf16 v90, v22, v46
  v_dot2c_f32_bf16 v91, v22, v54
  v_dot2c_f32_bf16 v92, v22, v62
  v_dot2c_f32_bf16 v93, v22, v70
  v_dot2c_f32_bf16 v94, v22, v78
  v_dot2c_f32_bf16 v95, v22, v86
  v_dot2c_f32_bf16 v88, v23, v31
  v_dot2c_f32_bf16 v89, v23, v39
  v_dot2c_f32_bf16 v90, v23, v47
  v_dot2c_f32_bf16 v91, v23, v55
  v_dot2c_f32_bf16 v92, v23, v63
  v_dot2c_f32_bf16 v93, v23, v71
  v_dot2c_f32_bf16 v94, v23, v79
  v_dot2c_f32_bf16 v95, v23, v87
  ds_read_b128 v[24:27], v2 offset:9440
  ds_read_b128 v[28:31], v2 offset:11744
  ds_read_b128 v[32:35], v2 offset:9408
  ds_read_b128 v[36:39], v2 offset:11712
  ds_read_b128 v[40:43], v2 offset:9376
  ds_read_b128 v[44:47], v2 offset:11680
  ds_read_b128 v[48:51], v2 offset:9344
  ds_read_b128 v[52:55], v2 offset:11648
  ds_read_b128 v[56:59], v2 offset:9312
  ds_read_b128 v[60:63], v2 offset:11616
  ds_read_b128 v[64:67], v2 offset:9280
  ds_read_b128 v[68:71], v2 offset:11584
  ds_read_b128 v[72:75], v2 offset:9248
  ds_read_b128 v[76:79], v2 offset:11552
  ds_read_b128 v[80:83], v2 offset:9216
  ds_read_b128 v[84:87], v2 offset:11520
  v_mov_b32 v4, 0xce6e6b28
  s_mov_b32 s48, 0x3eb8aa3b
  v_mul_f32 v88, s48, v88
  v_mul_f32 v89, s48, v89
  v_mul_f32 v90, s48, v90
  v_mul_f32 v91, s48, v91
  v_mul_f32 v92, s48, v92
  v_mul_f32 v93, s48, v93
  v_mul_f32 v94, s48, v94
  v_mul_f32 v95, s48, v95
  v_cmp_le_u32 vcc, 2, v3
  s_nop 1
  v_cndmask_b32 v89, v4, v89, vcc
  v_cmp_le_u32 vcc, 4, v3
  s_nop 1
  v_cndmask_b32 v90, v4, v90, vcc
  v_cmp_le_u32 vcc, 6, v3
  s_nop 1
  v_cndmask_b32 v91, v4, v91, vcc
  v_cmp_le_u32 vcc, 8, v3
  s_nop 1
  v_cndmask_b32 v92, v4, v92, vcc
  v_cmp_le_u32 vcc, 10, v3
  s_nop 1
  v_cndmask_b32 v93, v4, v93, vcc
  v_cmp_le_u32 vcc, 12, v3
  s_nop 1
  v_cndmask_b32 v94, v4, v94, vcc
  v_cmp_le_u32 vcc, 14, v3
  s_nop 1
  v_cndmask_b32 v95, v4, v95, vcc
  v_max3_f32 v5, v88, v89, v90
  v_max3_f32 v5, v5, v91, v92
  v_max3_f32 v5, v5, v93, v94
  v_max_f32 v5, v5, v95
  v_sub_f32 v88, v88, v5
  v_sub_f32 v89, v89, v5
  v_sub_f32 v90, v90, v5
  v_sub_f32 v91, v91, v5
  v_sub_f32 v92, v92, v5
  v_sub_f32 v93, v93, v5
  v_sub_f32 v94, v94, v5
  v_sub_f32 v95, v95, v5
  v_exp_f32 v88, v88
  v_exp_f32 v89, v89
  v_exp_f32 v90, v90
  v_exp_f32 v91, v91
  v_exp_f32 v92, v92
  v_exp_f32 v93, v93
  v_exp_f32 v94, v94
  v_exp_f32 v95, v95
  s_nop 0
  v_add_f32 v5, v88, v89
  v_add_f32 v5, v5, v90
  v_add_f32 v5, v5, v91
  v_add_f32 v5, v5, v92
  v_add_f32 v5, v5, v93
  v_add_f32 v5, v5, v94
  v_add_f32 v5, v5, v95
  v_rcp_f32 v5, v5
  s_nop 0
  v_mul_f32 v88, v88, v5
  v_mul_f32 v89, v89, v5
  v_mul_f32 v90, v90, v5
  v_mul_f32 v91, v91, v5
  v_mul_f32 v92, v92, v5
  v_mul_f32 v93, v93, v5
  v_mul_f32 v94, v94, v5
  v_mul_f32 v95, v95, v5
  v_cvt_pk_bf16_f32 v88, v88, 0
  v_cvt_pk_bf16_f32 v89, v89, 0
  v_cvt_pk_bf16_f32 v90, v90, 0
  v_cvt_pk_bf16_f32 v91, v91, 0
  v_cvt_pk_bf16_f32 v92, v92, 0
  v_cvt_pk_bf16_f32 v93, v93, 0
  v_cvt_pk_bf16_f32 v94, v94, 0
  v_cvt_pk_bf16_f32 v95, v95, 0
  v_mov_b32 v96, 0
  v_mov_b32 v97, 0
  v_mov_b32 v98, 0
  v_mov_b32 v99, 0
  v_mov_b32 v100, 0
  v_mov_b32 v101, 0
  v_mov_b32 v102, 0
  v_mov_b32 v103, 0
  v_mov_b32 v104, 0
  v_mov_b32 v105, 0
  v_mov_b32 v106, 0
  v_mov_b32 v107, 0
  v_mov_b32 v108, 0
  v_mov_b32 v109, 0
  v_mov_b32 v110, 0
  v_mov_b32 v111, 0
  s_waitcnt lgkmcnt(0)
  v_lshlrev_b32 v6, 16, v88
  v_dot2c_f32_bf16 v96, v24, v88
  v_dot2c_f32_bf16 v97, v24, v6
  v_dot2c_f32_bf16 v98, v25, v88
  v_dot2c_f32_bf16 v99, v25, v6
  v_dot2c_f32_bf16 v100, v26, v88
  v_dot2c_f32_bf16 v101, v26, v6
  v_dot2c_f32_bf16 v102, v27, v88
  v_dot2c_f32_bf16 v103, v27, v6
  v_dot2c_f32_bf16 v104, v28, v88
  v_dot2c_f32_bf16 v105, v28, v6
  v_dot2c_f32_bf16 v106, v29, v88
  v_dot2c_f32_bf16 v107, v29, v6
  v_dot2c_f32_bf16 v108, v30, v88
  v_dot2c_f32_bf16 v109, v30, v6
  v_dot2c_f32_bf16 v110, v31, v88
  v_dot2c_f32_bf16 v111, v31, v6
  v_lshlrev_b32 v6, 16, v89
  v_dot2c_f32_bf16 v96, v32, v89
  v_dot2c_f32_bf16 v97, v32, v6
  v_dot2c_f32_bf16 v98, v33, v89
  v_dot2c_f32_bf16 v99, v33, v6
  v_dot2c_f32_bf16 v100, v34, v89
  v_dot2c_f32_bf16 v101, v34, v6
  v_dot2c_f32_bf16 v102, v35, v89
  v_dot2c_f32_bf16 v103, v35, v6
  v_dot2c_f32_bf16 v104, v36, v89
  v_dot2c_f32_bf16 v105, v36, v6
  v_dot2c_f32_bf16 v106, v37, v89
  v_dot2c_f32_bf16 v107, v37, v6
  v_dot2c_f32_bf16 v108, v38, v89
  v_dot2c_f32_bf16 v109, v38, v6
  v_dot2c_f32_bf16 v110, v39, v89
  v_dot2c_f32_bf16 v111, v39, v6
  v_lshlrev_b32 v6, 16, v90
  v_dot2c_f32_bf16 v96, v40, v90
  v_dot2c_f32_bf16 v97, v40, v6
  v_dot2c_f32_bf16 v98, v41, v90
  v_dot2c_f32_bf16 v99, v41, v6
  v_dot2c_f32_bf16 v100, v42, v90
  v_dot2c_f32_bf16 v101, v42, v6
  v_dot2c_f32_bf16 v102, v43, v90
  v_dot2c_f32_bf16 v103, v43, v6
  v_dot2c_f32_bf16 v104, v44, v90
  v_dot2c_f32_bf16 v105, v44, v6
  v_dot2c_f32_bf16 v106, v45, v90
  v_dot2c_f32_bf16 v107, v45, v6
  v_dot2c_f32_bf16 v108, v46, v90
  v_dot2c_f32_bf16 v109, v46, v6
  v_dot2c_f32_bf16 v110, v47, v90
  v_dot2c_f32_bf16 v111, v47, v6
  v_lshlrev_b32 v6, 16, v91
  v_dot2c_f32_bf16 v96, v48, v91
  v_dot2c_f32_bf16 v97, v48, v6
  v_dot2c_f32_bf16 v98, v49, v91
  v_dot2c_f32_bf16 v99, v49, v6
  v_dot2c_f32_bf16 v100, v50, v91
  v_dot2c_f32_bf16 v101, v50, v6
  v_dot2c_f32_bf16 v102, v51, v91
  v_dot2c_f32_bf16 v103, v51, v6
  v_dot2c_f32_bf16 v104, v52, v91
  v_dot2c_f32_bf16 v105, v52, v6
  v_dot2c_f32_bf16 v106, v53, v91
  v_dot2c_f32_bf16 v107, v53, v6
  v_dot2c_f32_bf16 v108, v54, v91
  v_dot2c_f32_bf16 v109, v54, v6
  v_dot2c_f32_bf16 v110, v55, v91
  v_dot2c_f32_bf16 v111, v55, v6
  v_lshlrev_b32 v6, 16, v92
  v_dot2c_f32_bf16 v96, v56, v92
  v_dot2c_f32_bf16 v97, v56, v6
  v_dot2c_f32_bf16 v98, v57, v92
  v_dot2c_f32_bf16 v99, v57, v6
  v_dot2c_f32_bf16 v100, v58, v92
  v_dot2c_f32_bf16 v101, v58, v6
  v_dot2c_f32_bf16 v102, v59, v92
  v_dot2c_f32_bf16 v103, v59, v6
  v_dot2c_f32_bf16 v104, v60, v92
  v_dot2c_f32_bf16 v105, v60, v6
  v_dot2c_f32_bf16 v106, v61, v92
  v_dot2c_f32_bf16 v107, v61, v6
  v_dot2c_f32_bf16 v108, v62, v92
  v_dot2c_f32_bf16 v109, v62, v6
  v_dot2c_f32_bf16 v110, v63, v92
  v_dot2c_f32_bf16 v111, v63, v6
  v_lshlrev_b32 v6, 16, v93
  v_dot2c_f32_bf16 v96, v64, v93
  v_dot2c_f32_bf16 v97, v64, v6
  v_dot2c_f32_bf16 v98, v65, v93
  v_dot2c_f32_bf16 v99, v65, v6
  v_dot2c_f32_bf16 v100, v66, v93
  v_dot2c_f32_bf16 v101, v66, v6
  v_dot2c_f32_bf16 v102, v67, v93
  v_dot2c_f32_bf16 v103, v67, v6
  v_dot2c_f32_bf16 v104, v68, v93
  v_dot2c_f32_bf16 v105, v68, v6
  v_dot2c_f32_bf16 v106, v69, v93
  v_dot2c_f32_bf16 v107, v69, v6
  v_dot2c_f32_bf16 v108, v70, v93
  v_dot2c_f32_bf16 v109, v70, v6
  v_dot2c_f32_bf16 v110, v71, v93
  v_dot2c_f32_bf16 v111, v71, v6
  v_lshlrev_b32 v6, 16, v94
  v_dot2c_f32_bf16 v96, v72, v94
  v_dot2c_f32_bf16 v97, v72, v6
  v_dot2c_f32_bf16 v98, v73, v94
  v_dot2c_f32_bf16 v99, v73, v6
  v_dot2c_f32_bf16 v100, v74, v94
  v_dot2c_f32_bf16 v101, v74, v6
  v_dot2c_f32_bf16 v102, v75, v94
  v_dot2c_f32_bf16 v103, v75, v6
  v_dot2c_f32_bf16 v104, v76, v94
  v_dot2c_f32_bf16 v105, v76, v6
  v_dot2c_f32_bf16 v106, v77, v94
  v_dot2c_f32_bf16 v107, v77, v6
  v_dot2c_f32_bf16 v108, v78, v94
  v_dot2c_f32_bf16 v109, v78, v6
  v_dot2c_f32_bf16 v110, v79, v94
  v_dot2c_f32_bf16 v111, v79, v6
  v_lshlrev_b32 v6, 16, v95
  v_dot2c_f32_bf16 v96, v80, v95
  v_dot2c_f32_bf16 v97, v80, v6
  v_dot2c_f32_bf16 v98, v81, v95
  v_dot2c_f32_bf16 v99, v81, v6
  v_dot2c_f32_bf16 v100, v82, v95
  v_dot2c_f32_bf16 v101, v82, v6
  v_dot2c_f32_bf16 v102, v83, v95
  v_dot2c_f32_bf16 v103, v83, v6
  v_dot2c_f32_bf16 v104, v84, v95
  v_dot2c_f32_bf16 v105, v84, v6
  v_dot2c_f32_bf16 v106, v85, v95
  v_dot2c_f32_bf16 v107, v85, v6
  v_dot2c_f32_bf16 v108, v86, v95
  v_dot2c_f32_bf16 v109, v86, v6
  v_dot2c_f32_bf16 v110, v87, v95
  v_dot2c_f32_bf16 v111, v87, v6
  s_nop 2
  v_cvt_pk_bf16_f32 v16, v96, v97
  v_cvt_pk_bf16_f32 v17, v98, v99
  v_cvt_pk_bf16_f32 v18, v100, v101
  v_cvt_pk_bf16_f32 v19, v102, v103
  v_cvt_pk_bf16_f32 v20, v104, v105
  v_cvt_pk_bf16_f32 v21, v106, v107
  v_cvt_pk_bf16_f32 v22, v108, v109
  v_cvt_pk_bf16_f32 v23, v110, v111
  s_lshl_b32 s48, s29, 2
  s_add_u32 s48, s48, s25
  s_lshl_b32 s48, s48, 5
  s_add_u32 s48, s48, 8388608
  v_lshlrev_b32 v3, 10, v3
  buffer_store_dwordx4 v[16:19], v3, s[20:23], s48 offen
  buffer_store_dwordx4 v[20:23], v3, s[20:23], s48 offen offset:16
  s_endpgm
k1_zc:
  s_lshl_b32 s48, s2, 3
  s_add_u32 s48, s48, s24
  s_lshl_b32 s75, s48, 10
  v_lshlrev_b32 v160, 4, v1
  buffer_load_dwordx4 v[164:167], v160, s[12:15], s75 offen
  s_mov_b32 s84, s6
  s_and_b32 s85, s7, 0xffff
  s_mov_b32 s86, 1572864
  s_mov_b32 s87, 0x00020000
  buffer_load_dwordx4 v[164:167], v160, s[84:87], s75 offen
  s_mov_b32 s84, s8
  s_and_b32 s85, s9, 0xffff
  s_mov_b32 s86, 1409024
  s_mov_b32 s87, 0x00020000
  buffer_load_dwordx4 v[164:167], v160, s[84:87], s75 offen
  s_and_b32 s25, s24, 3
  s_lshr_b32 s26, s24, 2
  s_mul_i32 s30, s29, 5
  s_min_u32 s48, s29, 3
  s_add_u32 s30, s30, s48
  s_cmp_lt_u32 s29, 3
  s_cselect_b32 s50, 6, 5
  s_mul_i32 s49, s26, 3
  s_add_u32 s49, s49, 2
  s_cmp_lt_u32 s49, s50
  s_cselect_b32 s57, 1, 0
  v_and_b32 v15, 7, v13
  v_xor_b32 v15, v15, v14
  v_lshlrev_b32 v15, 4, v15
  v_lshl_add_u32 v15, v13, 7, v15
  s_lshl_b32 s48, s25, 12
  v_add_u32 v104, s48, v15
  v_xor_b32 v105, 64, v104
  v_bfe_u32 v15, v1, 2, 2
  v_lshl_add_u32 v15, v14, 3, v15
  v_mul_u32_u24 v15, 192, v15
  v_and_b32 v6, 1, v1
  v_lshl_add_u32 v15, v6, 3, v15
  v_bfe_u32 v6, v1, 1, 1
  v_and_b32 v7, 1, v14
  v_lshlrev_b32 v7, 1, v7
  s_mul_i32 s48, s26, 6
  s_add_u32 s49, s48, 0
  v_add_u32 v8, s49, v6
  v_xor_b32 v8, v8, v7
  v_lshl_add_u32 v8, v8, 4, v15
  v_add_u32 v106, 16384, v8
  s_add_u32 s49, s48, 2
  v_add_u32 v8, s49, v6
  v_xor_b32 v8, v8, v7
  v_lshl_add_u32 v8, v8, 4, v15
  v_add_u32 v107, 16384, v8
  s_add_u32 s49, s48, 4
  v_add_u32 v8, s49, v6
  v_xor_b32 v8, v8, v7
  v_lshl_add_u32 v8, v8, 4, v15
  v_add_u32 v108, 16384, v8
  v_add_u32 v109, 57344, v104
  v_add_u32 v110, 57344, v105
  v_add_u32 v111, 57344, v106
  v_add_u32 v112, 57344, v107
  v_add_u32 v113, 57344, v108
  v_mov_b32 v16, 0
  v_mov_b32 v17, 0
  v_mov_b32 v18, 0
  v_mov_b32 v19, 0
  v_mov_b32 v20, 0
  v_mov_b32 v21, 0
  v_mov_b32 v22, 0
  v_mov_b32 v23, 0
  v_mov_b32 v24, 0
  v_mov_b32 v25, 0
  v_mov_b32 v26, 0
  v_mov_b32 v27, 0
  v_mov_b32 v28, 0
  v_mov_b32 v29, 0
  v_mov_b32 v30, 0
  v_mov_b32 v31, 0
  v_mov_b32 v32, 0
  v_mov_b32 v33, 0
  v_mov_b32 v34, 0
  v_mov_b32 v35, 0
  v_mov_b32 v36, 0
  v_mov_b32 v37, 0
  v_mov_b32 v38, 0
  v_mov_b32 v39, 0
  v_mov_b32 v40, 0
  v_mov_b32 v41, 0
  v_mov_b32 v42, 0
  v_mov_b32 v43, 0
  v_mov_b32 v44, 0
  v_mov_b32 v45, 0
  v_mov_b32 v46, 0
  v_mov_b32 v47, 0
  v_mov_b32 v48, 0
  v_mov_b32 v49, 0
  v_mov_b32 v50, 0
  v_mov_b32 v51, 0
  v_mov_b32 v52, 0
  v_mov_b32 v53, 0
  v_mov_b32 v54, 0
  v_mov_b32 v55, 0
  v_mov_b32 v56, 0
  v_mov_b32 v57, 0
  v_mov_b32 v58, 0
  v_mov_b32 v59, 0
  v_mov_b32 v60, 0
  v_mov_b32 v61, 0
  v_mov_b32 v62, 0
  v_mov_b32 v63, 0
  v_mov_b32 v124, 0xbdd2d3e8
  v_mov_b32 v125, 0xbdd2d3e8
  v_mov_b32 v126, 0xc0135761
  v_mov_b32 v127, 0xc0135761
  v_mov_b32 v128, 1.0
  v_mov_b32 v129, 1.0
  s_lshl_b32 s48, s28, 7
  s_lshl_b32 s49, s25, 5
  s_add_u32 s48, s48, s49
  v_add_u32 v2, s48, v13
  s_movk_i32 s48, 2752
  v_mul_lo_u32 v2, v2, s48
  v_lshl_add_u32 v2, v14, 3, v2
  s_mul_i32 s49, s26, 3
  s_add_u32 s49, s49, s30
  s_lshl_b32 s58, s49, 5
  s_add_u32 s58, s58, 0
  s_lshl_b32 s48, s28, 7
  s_lshl_b32 s49, s25, 5
  s_add_u32 s48, s48, s49
  v_add_u32 v3, s48, v13
  v_mul_u32_u24 v3, 192, v3
  v_lshl_add_u32 v3, v14, 3, v3
  s_mul_i32 s56, s29, 393216
  s_mul_i32 s49, s26, 96
  s_add_u32 s56, s56, s49
  s_add_u32 s56, s56, 20971520
  s_mov_b32 s64, s60
  s_and_b32 s65, s61, 0xffff
  s_mov_b32 s66, 256
  s_mov_b32 s67, 0x00020000
  s_memrealtime s[90:91]
  s_waitcnt lgkmcnt(0)
  s_or_b32 s54, s90, 1
  v_mov_b32 v138, s54
  v_mov_b32 v139, 0
  v_mov_b32 v161, 0
  s_lshl_b32 s59, s28, 2
  s_cmp_ge_u32 s24, 1
  s_cbranch_scc1 k1n_34
  s_mov_b64 exec, 1
  buffer_atomic_cmpswap v[138:139], v161, s[64:67], s59 offen offset:64 sc0 sc1
  s_mov_b64 exec, -1
k1n_34:
  s_barrier
  ds_read_b64_tr_b16 v[64:65], v106 offset:0
  ds_read_b64_tr_b16 v[66:67], v106 offset:768
  ds_read_b64_tr_b16 v[68:69], v107 offset:0
  ds_read_b64_tr_b16 v[70:71], v107 offset:768
  ds_read_b64_tr_b16 v[72:73], v108 offset:0
  ds_read_b64_tr_b16 v[74:75], v108 offset:768
  ds_read_b128 v[76:79], v104 offset:0
  ds_read_b128 v[80:83], v104 offset:2048
  ds_read_b64_tr_b16 v[84:85], v106 offset:6144
  ds_read_b64_tr_b16 v[86:87], v106 offset:6912
  ds_read_b64_tr_b16 v[88:89], v107 offset:6144
  ds_read_b64_tr_b16 v[90:91], v107 offset:6912
  ds_read_b64_tr_b16 v[92:93], v108 offset:6144
  ds_read_b64_tr_b16 v[94:95], v108 offset:6912
  ds_read_b128 v[96:99], v105 offset:0
  ds_read_b128 v[100:103], v105 offset:2048
  s_waitcnt lgkmcnt(8)
  v_mfma_f32_16x16x32_bf16 v[16:19], v[64:67], v[76:79], v[16:19]
  v_mfma_f32_16x16x32_bf16 v[20:23], v[64:67], v[80:83], v[20:23]
  v_mfma_f32_16x16x32_bf16 v[24:27], v[68:71], v[76:79], v[24:27]
  v_mfma_f32_16x16x32_bf16 v[28:31], v[68:71], v[80:83], v[28:31]
  v_mfma_f32_16x16x32_bf16 v[32:35], v[72:75], v[76:79], v[32:35]
  v_mfma_f32_16x16x32_bf16 v[36:39], v[72:75], v[80:83], v[36:39]
  s_waitcnt lgkmcnt(0)
  s_barrier
  ds_read_b64_tr_b16 v[64:65], v106 offset:28672
  ds_read_b64_tr_b16 v[66:67], v106 offset:29440
  ds_read_b64_tr_b16 v[68:69], v107 offset:28672
  ds_read_b64_tr_b16 v[70:71], v107 offset:29440
  ds_read_b64_tr_b16 v[72:73], v108 offset:28672
  ds_read_b64_tr_b16 v[74:75], v108 offset:29440
  ds_read_b128 v[76:79], v104 offset:28672
  ds_read_b128 v[80:83], v104 offset:30720
  v_mfma_f32_16x16x32_bf16 v[16:19], v[84:87], v[96:99], v[16:19]
  v_mfma_f32_16x16x32_bf16 v[20:23], v[84:87], v[100:103], v[20:23]
  v_mfma_f32_16x16x32_bf16 v[24:27], v[88:91], v[96:99], v[24:27]
  v_mfma_f32_16x16x32_bf16 v[28:31], v[88:91], v[100:103], v[28:31]
  v_mfma_f32_16x16x32_bf16 v[32:35], v[92:95], v[96:99], v[32:35]
  v_mfma_f32_16x16x32_bf16 v[36:39], v[92:95], v[100:103], v[36:39]
  ds_read_b64_tr_b16 v[84:85], v106 offset:34816
  ds_read_b64_tr_b16 v[86:87], v106 offset:35584
  ds_read_b64_tr_b16 v[88:89], v107 offset:34816
  ds_read_b64_tr_b16 v[90:91], v107 offset:35584
  ds_read_b64_tr_b16 v[92:93], v108 offset:34816
  ds_read_b64_tr_b16 v[94:95], v108 offset:35584
  ds_read_b128 v[96:99], v105 offset:28672
  ds_read_b128 v[100:103], v105 offset:30720
  s_waitcnt lgkmcnt(8)
  v_mfma_f32_16x16x32_bf16 v[16:19], v[64:67], v[76:79], v[16:19]
  v_mfma_f32_16x16x32_bf16 v[20:23], v[64:67], v[80:83], v[20:23]
  v_mfma_f32_16x16x32_bf16 v[24:27], v[68:71], v[76:79], v[24:27]
  v_mfma_f32_16x16x32_bf16 v[28:31], v[68:71], v[80:83], v[28:31]
  v_mfma_f32_16x16x32_bf16 v[32:35], v[72:75], v[76:79], v[32:35]
  v_mfma_f32_16x16x32_bf16 v[36:39], v[72:75], v[80:83], v[36:39]
  s_waitcnt lgkmcnt(0)
  s_barrier
  ds_read_b64_tr_b16 v[64:65], v111 offset:0
  ds_read_b64_tr_b16 v[66:67], v111 offset:768
  ds_read_b64_tr_b16 v[68:69], v112 offset:0
  ds_read_b64_tr_b16 v[70:71], v112 offset:768
  ds_read_b64_tr_b16 v[72:73], v113 offset:0
  ds_read_b64_tr_b16 v[74:75], v113 offset:768
  ds_read_b128 v[76:79], v109 offset:0
  ds_read_b128 v[80:83], v109 offset:2048
  v_mfma_f32_16x16x32_bf16 v[16:19], v[84:87], v[96:99], v[16:19]
  v_mfma_f32_16x16x32_bf16 v[20:23], v[84:87], v[100:103], v[20:23]
  v_mfma_f32_16x16x32_bf16 v[24:27], v[88:91], v[96:99], v[24:27]
  v_mfma_f32_16x16x32_bf16 v[28:31], v[88:91], v[100:103], v[28:31]
  v_mfma_f32_16x16x32_bf16 v[32:35], v[92:95], v[96:99], v[32:35]
  v_mfma_f32_16x16x32_bf16 v[36:39], v[92:95], v[100:103], v[36:39]
  ds_read_b64_tr_b16 v[84:85], v111 offset:6144
  ds_read_b64_tr_b16 v[86:87], v111 offset:6912
  ds_read_b64_tr_b16 v[88:89], v112 offset:6144
  ds_read_b64_tr_b16 v[90:91], v112 offset:6912
  ds_read_b64_tr_b16 v[92:93], v113 offset:6144
  ds_read_b64_tr_b16 v[94:95], v113 offset:6912
  ds_read_b128 v[96:99], v110 offset:0
  ds_read_b128 v[100:103], v110 offset:2048
  s_waitcnt lgkmcnt(8)
  v_mfma_f32_16x16x32_bf16 v[16:19], v[64:67], v[76:79], v[16:19]
  v_mfma_f32_16x16x32_bf16 v[20:23], v[64:67], v[80:83], v[20:23]
  v_mfma_f32_16x16x32_bf16 v[24:27], v[68:71], v[76:79], v[24:27]
  v_mfma_f32_16x16x32_bf16 v[28:31], v[68:71], v[80:83], v[28:31]
  v_mfma_f32_16x16x32_bf16 v[32:35], v[72:75], v[76:79], v[32:35]
  v_mfma_f32_16x16x32_bf16 v[36:39], v[72:75], v[80:83], v[36:39]
  s_waitcnt lgkmcnt(0)
  s_barrier
  ds_read_b64_tr_b16 v[64:65], v111 offset:28672
  ds_read_b64_tr_b16 v[66:67], v111 offset:29440
  ds_read_b64_tr_b16 v[68:69], v112 offset:28672
  ds_read_b64_tr_b16 v[70:71], v112 offset:29440
  ds_read_b64_tr_b16 v[72:73], v113 offset:28672
  ds_read_b64_tr_b16 v[74:75], v113 offset:29440
  ds_read_b128 v[76:79], v109 offset:28672
  ds_read_b128 v[80:83], v109 offset:30720
  v_mfma_f32_16x16x32_bf16 v[16:19], v[84:87], v[96:99], v[16:19]
  v_mfma_f32_16x16x32_bf16 v[20:23], v[84:87], v[100:103], v[20:23]
  v_mfma_f32_16x16x32_bf16 v[24:27], v[88:91], v[96:99], v[24:27]
  v_mfma_f32_16x16x32_bf16 v[28:31], v[88:91], v[100:103], v[28:31]
  v_mfma_f32_16x16x32_bf16 v[32:35], v[92:95], v[96:99], v[32:35]
  v_mfma_f32_16x16x32_bf16 v[36:39], v[92:95], v[100:103], v[36:39]
  ds_read_b64_tr_b16 v[84:85], v111 offset:34816
  ds_read_b64_tr_b16 v[86:87], v111 offset:35584
  ds_read_b64_tr_b16 v[88:89], v112 offset:34816
  ds_read_b64_tr_b16 v[90:91], v112 offset:35584
  ds_read_b64_tr_b16 v[92:93], v113 offset:34816
  ds_read_b64_tr_b16 v[94:95], v113 offset:35584
  ds_read_b128 v[96:99], v110 offset:28672
  ds_read_b128 v[100:103], v110 offset:30720
  s_waitcnt lgkmcnt(8)
  v_mfma_f32_16x16x32_bf16 v[16:19], v[64:67], v[76:79], v[16:19]
  v_mfma_f32_16x16x32_bf16 v[20:23], v[64:67], v[80:83], v[20:23]
  v_mfma_f32_16x16x32_bf16 v[24:27], v[68:71], v[76:79], v[24:27]
  v_mfma_f32_16x16x32_bf16 v[28:31], v[68:71], v[80:83], v[28:31]
  v_mfma_f32_16x16x32_bf16 v[32:35], v[72:75], v[76:79], v[32:35]
  v_mfma_f32_16x16x32_bf16 v[36:39], v[72:75], v[80:83], v[36:39]
  s_waitcnt lgkmcnt(0)
  s_barrier
  ds_read_b64_tr_b16 v[64:65], v106 offset:0
  ds_read_b64_tr_b16 v[66:67], v106 offset:768
  ds_read_b64_tr_b16 v[68:69], v107 offset:0
  ds_read_b64_tr_b16 v[70:71], v107 offset:768
  ds_read_b64_tr_b16 v[72:73], v108 offset:0
  ds_read_b64_tr_b16 v[74:75], v108 offset:768
  ds_read_b128 v[76:79], v104 offset:0
  ds_read_b128 v[80:83], v104 offset:2048
  v_mfma_f32_16x16x32_bf16 v[16:19], v[84:87], v[96:99], v[16:19]
  v_mfma_f32_16x16x32_bf16 v[20:23], v[84:87], v[100:103], v[20:23]
  v_mfma_f32_16x16x32_bf16 v[24:27], v[88:91], v[96:99], v[24:27]
  v_mfma_f32_16x16x32_bf16 v[28:31], v[88:91], v[100:103], v[28:31]
  v_mfma_f32_16x16x32_bf16 v[32:35], v[92:95], v[96:99], v[32:35]
  v_mfma_f32_16x16x32_bf16 v[36:39], v[92:95], v[100:103], v[36:39]
  ds_read_b64_tr_b16 v[84:85], v106 offset:6144
  ds_read_b64_tr_b16 v[86:87], v106 offset:6912
  ds_read_b64_tr_b16 v[88:89], v107 offset:6144
  ds_read_b64_tr_b16 v[90:91], v107 offset:6912
  ds_read_b64_tr_b16 v[92:93], v108 offset:6144
  ds_read_b64_tr_b16 v[94:95], v108 offset:6912
  ds_read_b128 v[96:99], v105 offset:0
  ds_read_b128 v[100:103], v105 offset:2048
  s_waitcnt lgkmcnt(8)
  v_mfma_f32_16x16x32_bf16 v[16:19], v[64:67], v[76:79], v[16:19]
  v_mfma_f32_16x16x32_bf16 v[20:23], v[64:67], v[80:83], v[20:23]
  v_mfma_f32_16x16x32_bf16 v[24:27], v[68:71], v[76:79], v[24:27]
  v_mfma_f32_16x16x32_bf16 v[28:31], v[68:71], v[80:83], v[28:31]
  v_mfma_f32_16x16x32_bf16 v[32:35], v[72:75], v[76:79], v[32:35]
  v_mfma_f32_16x16x32_bf16 v[36:39], v[72:75], v[80:83], v[36:39]
  s_waitcnt lgkmcnt(0)
  s_barrier
  ds_read_b64_tr_b16 v[64:65], v106 offset:28672
  ds_read_b64_tr_b16 v[66:67], v106 offset:29440
  ds_read_b64_tr_b16 v[68:69], v107 offset:28672
  ds_read_b64_tr_b16 v[70:71], v107 offset:29440
  ds_read_b64_tr_b16 v[72:73], v108 offset:28672
  ds_read_b64_tr_b16 v[74:75], v108 offset:29440
  ds_read_b128 v[76:79], v104 offset:28672
  ds_read_b128 v[80:83], v104 offset:30720
  v_mfma_f32_16x16x32_bf16 v[16:19], v[84:87], v[96:99], v[16:19]
  v_mfma_f32_16x16x32_bf16 v[20:23], v[84:87], v[100:103], v[20:23]
  v_mfma_f32_16x16x32_bf16 v[24:27], v[88:91], v[96:99], v[24:27]
  v_mfma_f32_16x16x32_bf16 v[28:31], v[88:91], v[100:103], v[28:31]
  v_mfma_f32_16x16x32_bf16 v[32:35], v[92:95], v[96:99], v[32:35]
  v_mfma_f32_16x16x32_bf16 v[36:39], v[92:95], v[100:103], v[36:39]
  ds_read_b64_tr_b16 v[84:85], v106 offset:34816
  ds_read_b64_tr_b16 v[86:87], v106 offset:35584
  ds_read_b64_tr_b16 v[88:89], v107 offset:34816
  ds_read_b64_tr_b16 v[90:91], v107 offset:35584
  ds_read_b64_tr_b16 v[92:93], v108 offset:34816
  ds_read_b64_tr_b16 v[94:95], v108 offset:35584
  ds_read_b128 v[96:99], v105 offset:28672
  ds_read_b128 v[100:103], v105 offset:30720
  s_waitcnt lgkmcnt(8)
  v_mfma_f32_16x16x32_bf16 v[16:19], v[64:67], v[76:79], v[16:19]
  v_mfma_f32_16x16x32_bf16 v[20:23], v[64:67], v[80:83], v[20:23]
  v_mfma_f32_16x16x32_bf16 v[24:27], v[68:71], v[76:79], v[24:27]
  v_mfma_f32_16x16x32_bf16 v[28:31], v[68:71], v[80:83], v[28:31]
  v_mfma_f32_16x16x32_bf16 v[32:35], v[72:75], v[76:79], v[32:35]
  v_mfma_f32_16x16x32_bf16 v[36:39], v[72:75], v[80:83], v[36:39]
  s_waitcnt lgkmcnt(0)
  s_barrier
  ds_read_b64_tr_b16 v[64:65], v111 offset:0
  ds_read_b64_tr_b16 v[66:67], v111 offset:768
  ds_read_b64_tr_b16 v[68:69], v112 offset:0
  ds_read_b64_tr_b16 v[70:71], v112 offset:768
  ds_read_b64_tr_b16 v[72:73], v113 offset:0
  ds_read_b64_tr_b16 v[74:75], v113 offset:768
  ds_read_b128 v[76:79], v109 offset:0
  ds_read_b128 v[80:83], v109 offset:2048
  v_mfma_f32_16x16x32_bf16 v[16:19], v[84:87], v[96:99], v[16:19]
  v_mfma_f32_16x16x32_bf16 v[20:23], v[84:87], v[100:103], v[20:23]
  v_mfma_f32_16x16x32_bf16 v[24:27], v[88:91], v[96:99], v[24:27]
  v_mfma_f32_16x16x32_bf16 v[28:31], v[88:91], v[100:103], v[28:31]
  v_mfma_f32_16x16x32_bf16 v[32:35], v[92:95], v[96:99], v[32:35]
  v_mfma_f32_16x16x32_bf16 v[36:39], v[92:95], v[100:103], v[36:39]
  ds_read_b64_tr_b16 v[84:85], v111 offset:6144
  ds_read_b64_tr_b16 v[86:87], v111 offset:6912
  ds_read_b64_tr_b16 v[88:89], v112 offset:6144
  ds_read_b64_tr_b16 v[90:91], v112 offset:6912
  ds_read_b64_tr_b16 v[92:93], v113 offset:6144
  ds_read_b64_tr_b16 v[94:95], v113 offset:6912
  ds_read_b128 v[96:99], v110 offset:0
  ds_read_b128 v[100:103], v110 offset:2048
  s_waitcnt lgkmcnt(8)
  v_mfma_f32_16x16x32_bf16 v[16:19], v[64:67], v[76:79], v[16:19]
  v_mfma_f32_16x16x32_bf16 v[20:23], v[64:67], v[80:83], v[20:23]
  v_mfma_f32_16x16x32_bf16 v[24:27], v[68:71], v[76:79], v[24:27]
  v_mfma_f32_16x16x32_bf16 v[28:31], v[68:71], v[80:83], v[28:31]
  v_mfma_f32_16x16x32_bf16 v[32:35], v[72:75], v[76:79], v[32:35]
  v_mfma_f32_16x16x32_bf16 v[36:39], v[72:75], v[80:83], v[36:39]
  s_waitcnt lgkmcnt(0)
  s_barrier
  ds_read_b64_tr_b16 v[64:65], v111 offset:28672
  ds_read_b64_tr_b16 v[66:67], v111 offset:29440
  ds_read_b64_tr_b16 v[68:69], v112 offset:28672
  ds_read_b64_tr_b16 v[70:71], v112 offset:29440
  ds_read_b64_tr_b16 v[72:73], v113 offset:28672
  ds_read_b64_tr_b16 v[74:75], v113 offset:29440
  ds_read_b128 v[76:79], v109 offset:28672
  ds_read_b128 v[80:83], v109 offset:30720
  v_mfma_f32_16x16x32_bf16 v[16:19], v[84:87], v[96:99], v[16:19]
  v_mfma_f32_16x16x32_bf16 v[20:23], v[84:87], v[100:103], v[20:23]
  v_mfma_f32_16x16x32_bf16 v[24:27], v[88:91], v[96:99], v[24:27]
  v_mfma_f32_16x16x32_bf16 v[28:31], v[88:91], v[100:103], v[28:31]
  v_mfma_f32_16x16x32_bf16 v[32:35], v[92:95], v[96:99], v[32:35]
  v_mfma_f32_16x16x32_bf16 v[36:39], v[92:95], v[100:103], v[36:39]
  ds_read_b64_tr_b16 v[84:85], v111 offset:34816
  ds_read_b64_tr_b16 v[86:87], v111 offset:35584
  ds_read_b64_tr_b16 v[88:89], v112 offset:34816
  ds_read_b64_tr_b16 v[90:91], v112 offset:35584
  ds_read_b64_tr_b16 v[92:93], v113 offset:34816
  ds_read_b64_tr_b16 v[94:95], v113 offset:35584
  ds_read_b128 v[96:99], v110 offset:28672
  ds_read_b128 v[100:103], v110 offset:30720
  s_waitcnt lgkmcnt(8)
  v_mfma_f32_16x16x32_bf16 v[16:19], v[64:67], v[76:79], v[16:19]
  v_mfma_f32_16x16x32_bf16 v[20:23], v[64:67], v[80:83], v[20:23]
  v_mfma_f32_16x16x32_bf16 v[24:27], v[68:71], v[76:79], v[24:27]
  v_mfma_f32_16x16x32_bf16 v[28:31], v[68:71], v[80:83], v[28:31]
  v_mfma_f32_16x16x32_bf16 v[32:35], v[72:75], v[76:79], v[32:35]
  v_mfma_f32_16x16x32_bf16 v[36:39], v[72:75], v[80:83], v[36:39]
  s_waitcnt lgkmcnt(0)
  s_barrier
  ds_read_b64_tr_b16 v[64:65], v106 offset:0
  ds_read_b64_tr_b16 v[66:67], v106 offset:768
  ds_read_b64_tr_b16 v[68:69], v107 offset:0
  ds_read_b64_tr_b16 v[70:71], v107 offset:768
  ds_read_b64_tr_b16 v[72:73], v108 offset:0
  ds_read_b64_tr_b16 v[74:75], v108 offset:768
  ds_read_b128 v[76:79], v104 offset:0
  ds_read_b128 v[80:83], v104 offset:2048
  v_mfma_f32_16x16x32_bf16 v[16:19], v[84:87], v[96:99], v[16:19]
  v_mfma_f32_16x16x32_bf16 v[20:23], v[84:87], v[100:103], v[20:23]
  v_mfma_f32_16x16x32_bf16 v[24:27], v[88:91], v[96:99], v[24:27]
  v_mfma_f32_16x16x32_bf16 v[28:31], v[88:91], v[100:103], v[28:31]
  v_mfma_f32_16x16x32_bf16 v[32:35], v[92:95], v[96:99], v[32:35]
  v_mfma_f32_16x16x32_bf16 v[36:39], v[92:95], v[100:103], v[36:39]
  s_nop 7
  s_nop 7
  v_mov_b32 v140, 0
  v_mov_b32 v141, 0
  v_mov_b32 v142, 0
  v_mov_b32 v143, 0
  v_pk_mul_f32 v[130:131], v[16:17], v[16:17]
  v_pk_mul_f32 v[132:133], v[18:19], v[18:19]
  v_pk_mul_f32 v[134:135], v[20:21], v[20:21]
  v_pk_mul_f32 v[136:137], v[22:23], v[22:23]
  v_pk_fma_f32 v[130:131], v[130:131], v[124:125], v[126:127]
  v_pk_fma_f32 v[132:133], v[132:133], v[124:125], v[126:127]
  v_pk_fma_f32 v[134:135], v[134:135], v[124:125], v[126:127]
  v_pk_fma_f32 v[136:137], v[136:137], v[124:125], v[126:127]
  v_pk_mul_f32 v[130:131], v[130:131], v[16:17]
  v_pk_mul_f32 v[132:133], v[132:133], v[18:19]
  v_pk_mul_f32 v[134:135], v[134:135], v[20:21]
  v_pk_mul_f32 v[136:137], v[136:137], v[22:23]
  v_exp_f32 v130, v130
  v_exp_f32 v131, v131
  v_exp_f32 v132, v132
  v_exp_f32 v133, v133
  v_exp_f32 v134, v134
  v_exp_f32 v135, v135
  v_exp_f32 v136, v136
  v_exp_f32 v137, v137
  s_nop 0
  v_pk_add_f32 v[130:131], v[130:131], v[128:129]
  v_pk_add_f32 v[132:133], v[132:133], v[128:129]
  v_pk_add_f32 v[134:135], v[134:135], v[128:129]
  v_pk_add_f32 v[136:137], v[136:137], v[128:129]
  v_rcp_f32 v130, v130
  v_rcp_f32 v131, v131
  v_rcp_f32 v132, v132
  v_rcp_f32 v133, v133
  v_rcp_f32 v134, v134
  v_rcp_f32 v135, v135
  v_rcp_f32 v136, v136
  v_rcp_f32 v137, v137
  s_nop 0
  v_pk_mul_f32 v[16:17], v[16:17], v[130:131]
  v_pk_mul_f32 v[18:19], v[18:19], v[132:133]
  v_pk_mul_f32 v[20:21], v[20:21], v[134:135]
  v_pk_mul_f32 v[22:23], v[22:23], v[136:137]
  v_add_f32 v140, v140, v16
  v_fmac_f32 v141, v16, v16
  v_add_f32 v140, v140, v17
  v_fmac_f32 v141, v17, v17
  v_add_f32 v140, v140, v18
  v_fmac_f32 v141, v18, v18
  v_add_f32 v140, v140, v19
  v_fmac_f32 v141, v19, v19
  v_add_f32 v142, v142, v20
  v_fmac_f32 v143, v20, v20
  v_add_f32 v142, v142, v21
  v_fmac_f32 v143, v21, v21
  v_add_f32 v142, v142, v22
  v_fmac_f32 v143, v22, v22
  v_add_f32 v142, v142, v23
  v_fmac_f32 v143, v23, v23
  v_pk_mul_f32 v[130:131], v[24:25], v[24:25]
  v_pk_mul_f32 v[132:133], v[26:27], v[26:27]
  v_pk_mul_f32 v[134:135], v[28:29], v[28:29]
  v_pk_mul_f32 v[136:137], v[30:31], v[30:31]
  v_pk_fma_f32 v[130:131], v[130:131], v[124:125], v[126:127]
  v_pk_fma_f32 v[132:133], v[132:133], v[124:125], v[126:127]
  v_pk_fma_f32 v[134:135], v[134:135], v[124:125], v[126:127]
  v_pk_fma_f32 v[136:137], v[136:137], v[124:125], v[126:127]
  v_pk_mul_f32 v[130:131], v[130:131], v[24:25]
  v_pk_mul_f32 v[132:133], v[132:133], v[26:27]
  v_pk_mul_f32 v[134:135], v[134:135], v[28:29]
  v_pk_mul_f32 v[136:137], v[136:137], v[30:31]
  v_exp_f32 v130, v130
  v_exp_f32 v131, v131
  v_exp_f32 v132, v132
  v_exp_f32 v133, v133
  v_exp_f32 v134, v134
  v_exp_f32 v135, v135
  v_exp_f32 v136, v136
  v_exp_f32 v137, v137
  s_nop 0
  v_pk_add_f32 v[130:131], v[130:131], v[128:129]
  v_pk_add_f32 v[132:133], v[132:133], v[128:129]
  v_pk_add_f32 v[134:135], v[134:135], v[128:129]
  v_pk_add_f32 v[136:137], v[136:137], v[128:129]
  v_rcp_f32 v130, v130
  v_rcp_f32 v131, v131
  v_rcp_f32 v132, v132
  v_rcp_f32 v133, v133
  v_rcp_f32 v134, v134
  v_rcp_f32 v135, v135
  v_rcp_f32 v136, v136
  v_rcp_f32 v137, v137
  s_nop 0
  v_pk_mul_f32 v[24:25], v[24:25], v[130:131]
  v_pk_mul_f32 v[26:27], v[26:27], v[132:133]
  v_pk_mul_f32 v[28:29], v[28:29], v[134:135]
  v_pk_mul_f32 v[30:31], v[30:31], v[136:137]
  v_add_f32 v140, v140, v24
  v_fmac_f32 v141, v24, v24
  v_add_f32 v140, v140, v25
  v_fmac_f32 v141, v25, v25
  v_add_f32 v140, v140, v26
  v_fmac_f32 v141, v26, v26
  v_add_f32 v140, v140, v27
  v_fmac_f32 v141, v27, v27
  v_add_f32 v142, v142, v28
  v_fmac_f32 v143, v28, v28
  v_add_f32 v142, v142, v29
  v_fmac_f32 v143, v29, v29
  v_add_f32 v142, v142, v30
  v_fmac_f32 v143, v30, v30
  v_add_f32 v142, v142, v31
  v_fmac_f32 v143, v31, v31
  s_cmp_eq_u32 s57, 0
  s_cbranch_scc1 k1z_35
  v_pk_mul_f32 v[130:131], v[32:33], v[32:33]
  v_pk_mul_f32 v[132:133], v[34:35], v[34:35]
  v_pk_mul_f32 v[134:135], v[36:37], v[36:37]
  v_pk_mul_f32 v[136:137], v[38:39], v[38:39]
  v_pk_fma_f32 v[130:131], v[130:131], v[124:125], v[126:127]
  v_pk_fma_f32 v[132:133], v[132:133], v[124:125], v[126:127]
  v_pk_fma_f32 v[134:135], v[134:135], v[124:125], v[126:127]
  v_pk_fma_f32 v[136:137], v[136:137], v[124:125], v[126:127]
  v_pk_mul_f32 v[130:131], v[130:131], v[32:33]
  v_pk_mul_f32 v[132:133], v[132:133], v[34:35]
  v_pk_mul_f32 v[134:135], v[134:135], v[36:37]
  v_pk_mul_f32 v[136:137], v[136:137], v[38:39]
  v_exp_f32 v130, v130
  v_exp_f32 v131, v131
  v_exp_f32 v132, v132
  v_exp_f32 v133, v133
  v_exp_f32 v134, v134
  v_exp_f32 v135, v135
  v_exp_f32 v136, v136
  v_exp_f32 v137, v137
  s_nop 0
  v_pk_add_f32 v[130:131], v[130:131], v[128:129]
  v_pk_add_f32 v[132:133], v[132:133], v[128:129]
  v_pk_add_f32 v[134:135], v[134:135], v[128:129]
  v_pk_add_f32 v[136:137], v[136:137], v[128:129]
  v_rcp_f32 v130, v130
  v_rcp_f32 v131, v131
  v_rcp_f32 v132, v132
  v_rcp_f32 v133, v133
  v_rcp_f32 v134, v134
  v_rcp_f32 v135, v135
  v_rcp_f32 v136, v136
  v_rcp_f32 v137, v137
  s_nop 0
  v_pk_mul_f32 v[32:33], v[32:33], v[130:131]
  v_pk_mul_f32 v[34:35], v[34:35], v[132:133]
  v_pk_mul_f32 v[36:37], v[36:37], v[134:135]
  v_pk_mul_f32 v[38:39], v[38:39], v[136:137]
  v_add_f32 v140, v140, v32
  v_fmac_f32 v141, v32, v32
  v_add_f32 v140, v140, v33
  v_fmac_f32 v141, v33, v33
  v_add_f32 v140, v140, v34
  v_fmac_f32 v141, v34, v34
  v_add_f32 v140, v140, v35
  v_fmac_f32 v141, v35, v35
  v_add_f32 v142, v142, v36
  v_fmac_f32 v143, v36, v36
  v_add_f32 v142, v142, v37
  v_fmac_f32 v143, v37, v37
  v_add_f32 v142, v142, v38
  v_fmac_f32 v143, v38, v38
  v_add_f32 v142, v142, v39
  v_fmac_f32 v143, v39, v39
k1z_35:
  s_lshl_b32 s48, s26, 12
  s_lshl_b32 s49, s25, 8
  s_add_u32 s48, s48, s49
  s_add_u32 s48, s48, 114688
  v_lshlrev_b32 v4, 10, v14
  v_lshl_add_u32 v4, v13, 3, v4
  v_add_u32 v4, s48, v4
  ds_write_b64 v4, v[140:141] offset:0
  ds_write_b64 v4, v[142:143] offset:128
  s_cmp_ge_u32 s24, 1
  s_cbranch_scc1 k1n_36
  s_waitcnt vmcnt(0)
  v_readfirstlane_b32 s53, v138
  s_cmp_eq_u32 s53, 0
  s_cselect_b32 s54, s54, s53
  v_mov_b32 v5, s54
  v_mov_b32 v6, 123904
  ds_write_b32 v6, v5
k1n_36:
  s_waitcnt lgkmcnt(0)
  s_barrier
  s_cmp_ge_u32 s24, 2
  s_cbranch_scc1 k1p_37
  v_lshlrev_b32 v4, 3, v0
  v_add_u32 v4, 114688, v4
  ds_read_b64 v[144:145], v4 offset:0
  ds_read_b64 v[146:147], v4 offset:1024
  ds_read_b64 v[148:149], v4 offset:2048
  ds_read_b64 v[150:151], v4 offset:3072
  ds_read_b64 v[152:153], v4 offset:4096
  ds_read_b64 v[154:155], v4 offset:5120
  ds_read_b64 v[156:157], v4 offset:6144
  ds_read_b64 v[158:159], v4 offset:7168
  s_waitcnt lgkmcnt(0)
  v_add_f32 v144, v144, v146
  v_add_f32 v145, v145, v147
  v_add_f32 v144, v144, v148
  v_add_f32 v145, v145, v149
  v_add_f32 v144, v144, v150
  v_add_f32 v145, v145, v151
  v_add_f32 v144, v144, v152
  v_add_f32 v145, v145, v153
  v_add_f32 v144, v144, v154
  v_add_f32 v145, v145, v155
  v_add_f32 v144, v144, v156
  v_add_f32 v145, v145, v157
  v_add_f32 v144, v144, v158
  v_add_f32 v145, v145, v159
  v_mov_b32 v6, 123904
  ds_read_b32 v147, v6
  v_mov_b32 v146, v145
  s_waitcnt lgkmcnt(0)
  v_mov_b32 v145, v147
  s_lshl_b32 s48, s28, 7
  v_add_u32 v4, s48, v0
  v_lshlrev_b32 v4, 4, v4
  s_lshl_b32 s48, s29, 15
  s_add_u32 s48, s48, 16777216
  buffer_store_dwordx4 v[144:147], v4, s[20:23], s48 offen sc0 sc1
k1p_37:
  ds_read_b64_tr_b16 v[84:85], v106 offset:6144
  ds_read_b64_tr_b16 v[86:87], v106 offset:6912
  ds_read_b64_tr_b16 v[88:89], v107 offset:6144
  ds_read_b64_tr_b16 v[90:91], v107 offset:6912
  ds_read_b64_tr_b16 v[92:93], v108 offset:6144
  ds_read_b64_tr_b16 v[94:95], v108 offset:6912
  ds_read_b128 v[96:99], v105 offset:0
  ds_read_b128 v[100:103], v105 offset:2048
  s_waitcnt lgkmcnt(8)
  v_mfma_f32_16x16x32_bf16 v[40:43], v[64:67], v[76:79], v[40:43]
  v_mfma_f32_16x16x32_bf16 v[44:47], v[64:67], v[80:83], v[44:47]
  v_mfma_f32_16x16x32_bf16 v[48:51], v[68:71], v[76:79], v[48:51]
  v_mfma_f32_16x16x32_bf16 v[52:55], v[68:71], v[80:83], v[52:55]
  v_mfma_f32_16x16x32_bf16 v[56:59], v[72:75], v[76:79], v[56:59]
  v_mfma_f32_16x16x32_bf16 v[60:63], v[72:75], v[80:83], v[60:63]
  s_waitcnt lgkmcnt(0)
  s_barrier
  ds_read_b64_tr_b16 v[64:65], v106 offset:28672
  ds_read_b64_tr_b16 v[66:67], v106 offset:29440
  ds_read_b64_tr_b16 v[68:69], v107 offset:28672
  ds_read_b64_tr_b16 v[70:71], v107 offset:29440
  ds_read_b64_tr_b16 v[72:73], v108 offset:28672
  ds_read_b64_tr_b16 v[74:75], v108 offset:29440
  ds_read_b128 v[76:79], v104 offset:28672
  ds_read_b128 v[80:83], v104 offset:30720
  v_mfma_f32_16x16x32_bf16 v[40:43], v[84:87], v[96:99], v[40:43]
  v_mfma_f32_16x16x32_bf16 v[44:47], v[84:87], v[100:103], v[44:47]
  v_mfma_f32_16x16x32_bf16 v[48:51], v[88:91], v[96:99], v[48:51]
  v_mfma_f32_16x16x32_bf16 v[52:55], v[88:91], v[100:103], v[52:55]
  v_mfma_f32_16x16x32_bf16 v[56:59], v[92:95], v[96:99], v[56:59]
  v_mfma_f32_16x16x32_bf16 v[60:63], v[92:95], v[100:103], v[60:63]
  ds_read_b64_tr_b16 v[84:85], v106 offset:34816
  ds_read_b64_tr_b16 v[86:87], v106 offset:35584
  ds_read_b64_tr_b16 v[88:89], v107 offset:34816
  ds_read_b64_tr_b16 v[90:91], v107 offset:35584
  ds_read_b64_tr_b16 v[92:93], v108 offset:34816
  ds_read_b64_tr_b16 v[94:95], v108 offset:35584
  ds_read_b128 v[96:99], v105 offset:28672
  ds_read_b128 v[100:103], v105 offset:30720
  s_waitcnt lgkmcnt(8)
  v_mfma_f32_16x16x32_bf16 v[40:43], v[64:67], v[76:79], v[40:43]
  v_mfma_f32_16x16x32_bf16 v[44:47], v[64:67], v[80:83], v[44:47]
  v_mfma_f32_16x16x32_bf16 v[48:51], v[68:71], v[76:79], v[48:51]
  v_mfma_f32_16x16x32_bf16 v[52:55], v[68:71], v[80:83], v[52:55]
  v_mfma_f32_16x16x32_bf16 v[56:59], v[72:75], v[76:79], v[56:59]
  v_mfma_f32_16x16x32_bf16 v[60:63], v[72:75], v[80:83], v[60:63]
  s_waitcnt lgkmcnt(0)
  s_barrier
  ds_read_b64_tr_b16 v[64:65], v111 offset:0
  ds_read_b64_tr_b16 v[66:67], v111 offset:768
  ds_read_b64_tr_b16 v[68:69], v112 offset:0
  ds_read_b64_tr_b16 v[70:71], v112 offset:768
  ds_read_b64_tr_b16 v[72:73], v113 offset:0
  ds_read_b64_tr_b16 v[74:75], v113 offset:768
  ds_read_b128 v[76:79], v109 offset:0
  ds_read_b128 v[80:83], v109 offset:2048
  v_mfma_f32_16x16x32_bf16 v[40:43], v[84:87], v[96:99], v[40:43]
  v_mfma_f32_16x16x32_bf16 v[44:47], v[84:87], v[100:103], v[44:47]
  v_mfma_f32_16x16x32_bf16 v[48:51], v[88:91], v[96:99], v[48:51]
  v_mfma_f32_16x16x32_bf16 v[52:55], v[88:91], v[100:103], v[52:55]
  v_mfma_f32_16x16x32_bf16 v[56:59], v[92:95], v[96:99], v[56:59]
  v_mfma_f32_16x16x32_bf16 v[60:63], v[92:95], v[100:103], v[60:63]
  ds_read_b64_tr_b16 v[84:85], v111 offset:6144
  ds_read_b64_tr_b16 v[86:87], v111 offset:6912
  ds_read_b64_tr_b16 v[88:89], v112 offset:6144
  ds_read_b64_tr_b16 v[90:91], v112 offset:6912
  ds_read_b64_tr_b16 v[92:93], v113 offset:6144
  ds_read_b64_tr_b16 v[94:95], v113 offset:6912
  ds_read_b128 v[96:99], v110 offset:0
  ds_read_b128 v[100:103], v110 offset:2048
  s_waitcnt lgkmcnt(8)
  v_mfma_f32_16x16x32_bf16 v[40:43], v[64:67], v[76:79], v[40:43]
  v_mfma_f32_16x16x32_bf16 v[44:47], v[64:67], v[80:83], v[44:47]
  v_mfma_f32_16x16x32_bf16 v[48:51], v[68:71], v[76:79], v[48:51]
  v_mfma_f32_16x16x32_bf16 v[52:55], v[68:71], v[80:83], v[52:55]
  v_mfma_f32_16x16x32_bf16 v[56:59], v[72:75], v[76:79], v[56:59]
  v_mfma_f32_16x16x32_bf16 v[60:63], v[72:75], v[80:83], v[60:63]
  s_waitcnt lgkmcnt(0)
  s_barrier
  ds_read_b64_tr_b16 v[64:65], v111 offset:28672
  ds_read_b64_tr_b16 v[66:67], v111 offset:29440
  ds_read_b64_tr_b16 v[68:69], v112 offset:28672
  ds_read_b64_tr_b16 v[70:71], v112 offset:29440
  ds_read_b64_tr_b16 v[72:73], v113 offset:28672
  ds_read_b64_tr_b16 v[74:75], v113 offset:29440
  ds_read_b128 v[76:79], v109 offset:28672
  ds_read_b128 v[80:83], v109 offset:30720
  v_mfma_f32_16x16x32_bf16 v[40:43], v[84:87], v[96:99], v[40:43]
  v_mfma_f32_16x16x32_bf16 v[44:47], v[84:87], v[100:103], v[44:47]
  v_mfma_f32_16x16x32_bf16 v[48:51], v[88:91], v[96:99], v[48:51]
  v_mfma_f32_16x16x32_bf16 v[52:55], v[88:91], v[100:103], v[52:55]
  v_mfma_f32_16x16x32_bf16 v[56:59], v[92:95], v[96:99], v[56:59]
  v_mfma_f32_16x16x32_bf16 v[60:63], v[92:95], v[100:103], v[60:63]
  ds_read_b64_tr_b16 v[84:85], v111 offset:34816
  ds_read_b64_tr_b16 v[86:87], v111 offset:35584
  ds_read_b64_tr_b16 v[88:89], v112 offset:34816
  ds_read_b64_tr_b16 v[90:91], v112 offset:35584
  ds_read_b64_tr_b16 v[92:93], v113 offset:34816
  ds_read_b64_tr_b16 v[94:95], v113 offset:35584
  ds_read_b128 v[96:99], v110 offset:28672
  ds_read_b128 v[100:103], v110 offset:30720
  s_waitcnt lgkmcnt(8)
  v_mfma_f32_16x16x32_bf16 v[40:43], v[64:67], v[76:79], v[40:43]
  v_mfma_f32_16x16x32_bf16 v[44:47], v[64:67], v[80:83], v[44:47]
  v_mfma_f32_16x16x32_bf16 v[48:51], v[68:71], v[76:79], v[48:51]
  v_mfma_f32_16x16x32_bf16 v[52:55], v[68:71], v[80:83], v[52:55]
  v_mfma_f32_16x16x32_bf16 v[56:59], v[72:75], v[76:79], v[56:59]
  v_mfma_f32_16x16x32_bf16 v[60:63], v[72:75], v[80:83], v[60:63]
  s_waitcnt lgkmcnt(0)
  s_barrier
  ds_read_b64_tr_b16 v[64:65], v106 offset:0
  ds_read_b64_tr_b16 v[66:67], v106 offset:768
  ds_read_b64_tr_b16 v[68:69], v107 offset:0
  ds_read_b64_tr_b16 v[70:71], v107 offset:768
  ds_read_b64_tr_b16 v[72:73], v108 offset:0
  ds_read_b64_tr_b16 v[74:75], v108 offset:768
  ds_read_b128 v[76:79], v104 offset:0
  ds_read_b128 v[80:83], v104 offset:2048
  v_mfma_f32_16x16x32_bf16 v[40:43], v[84:87], v[96:99], v[40:43]
  v_mfma_f32_16x16x32_bf16 v[44:47], v[84:87], v[100:103], v[44:47]
  v_mfma_f32_16x16x32_bf16 v[48:51], v[88:91], v[96:99], v[48:51]
  v_mfma_f32_16x16x32_bf16 v[52:55], v[88:91], v[100:103], v[52:55]
  v_mfma_f32_16x16x32_bf16 v[56:59], v[92:95], v[96:99], v[56:59]
  v_mfma_f32_16x16x32_bf16 v[60:63], v[92:95], v[100:103], v[60:63]
  ds_read_b64_tr_b16 v[84:85], v106 offset:6144
  ds_read_b64_tr_b16 v[86:87], v106 offset:6912
  ds_read_b64_tr_b16 v[88:89], v107 offset:6144
  ds_read_b64_tr_b16 v[90:91], v107 offset:6912
  ds_read_b64_tr_b16 v[92:93], v108 offset:6144
  ds_read_b64_tr_b16 v[94:95], v108 offset:6912
  ds_read_b128 v[96:99], v105 offset:0
  ds_read_b128 v[100:103], v105 offset:2048
  s_waitcnt lgkmcnt(8)
  v_mfma_f32_16x16x32_bf16 v[40:43], v[64:67], v[76:79], v[40:43]
  v_mfma_f32_16x16x32_bf16 v[44:47], v[64:67], v[80:83], v[44:47]
  v_mfma_f32_16x16x32_bf16 v[48:51], v[68:71], v[76:79], v[48:51]
  v_mfma_f32_16x16x32_bf16 v[52:55], v[68:71], v[80:83], v[52:55]
  v_mfma_f32_16x16x32_bf16 v[56:59], v[72:75], v[76:79], v[56:59]
  v_mfma_f32_16x16x32_bf16 v[60:63], v[72:75], v[80:83], v[60:63]
  s_waitcnt lgkmcnt(0)
  s_barrier
  ds_read_b64_tr_b16 v[64:65], v106 offset:28672
  ds_read_b64_tr_b16 v[66:67], v106 offset:29440
  ds_read_b64_tr_b16 v[68:69], v107 offset:28672
  ds_read_b64_tr_b16 v[70:71], v107 offset:29440
  ds_read_b64_tr_b16 v[72:73], v108 offset:28672
  ds_read_b64_tr_b16 v[74:75], v108 offset:29440
  ds_read_b128 v[76:79], v104 offset:28672
  ds_read_b128 v[80:83], v104 offset:30720
  v_mfma_f32_16x16x32_bf16 v[40:43], v[84:87], v[96:99], v[40:43]
  v_mfma_f32_16x16x32_bf16 v[44:47], v[84:87], v[100:103], v[44:47]
  v_mfma_f32_16x16x32_bf16 v[48:51], v[88:91], v[96:99], v[48:51]
  v_mfma_f32_16x16x32_bf16 v[52:55], v[88:91], v[100:103], v[52:55]
  v_mfma_f32_16x16x32_bf16 v[56:59], v[92:95], v[96:99], v[56:59]
  v_mfma_f32_16x16x32_bf16 v[60:63], v[92:95], v[100:103], v[60:63]
  ds_read_b64_tr_b16 v[84:85], v106 offset:34816
  ds_read_b64_tr_b16 v[86:87], v106 offset:35584
  ds_read_b64_tr_b16 v[88:89], v107 offset:34816
  ds_read_b64_tr_b16 v[90:91], v107 offset:35584
  ds_read_b64_tr_b16 v[92:93], v108 offset:34816
  ds_read_b64_tr_b16 v[94:95], v108 offset:35584
  ds_read_b128 v[96:99], v105 offset:28672
  ds_read_b128 v[100:103], v105 offset:30720
  s_waitcnt lgkmcnt(8)
  v_mfma_f32_16x16x32_bf16 v[40:43], v[64:67], v[76:79], v[40:43]
  v_mfma_f32_16x16x32_bf16 v[44:47], v[64:67], v[80:83], v[44:47]
  v_mfma_f32_16x16x32_bf16 v[48:51], v[68:71], v[76:79], v[48:51]
  v_mfma_f32_16x16x32_bf16 v[52:55], v[68:71], v[80:83], v[52:55]
  v_mfma_f32_16x16x32_bf16 v[56:59], v[72:75], v[76:79], v[56:59]
  v_mfma_f32_16x16x32_bf16 v[60:63], v[72:75], v[80:83], v[60:63]
  s_waitcnt lgkmcnt(0)
  s_barrier
  ds_read_b64_tr_b16 v[64:65], v111 offset:0
  ds_read_b64_tr_b16 v[66:67], v111 offset:768
  ds_read_b64_tr_b16 v[68:69], v112 offset:0
  ds_read_b64_tr_b16 v[70:71], v112 offset:768
  ds_read_b64_tr_b16 v[72:73], v113 offset:0
  ds_read_b64_tr_b16 v[74:75], v113 offset:768
  ds_read_b128 v[76:79], v109 offset:0
  ds_read_b128 v[80:83], v109 offset:2048
  v_mfma_f32_16x16x32_bf16 v[40:43], v[84:87], v[96:99], v[40:43]
  v_mfma_f32_16x16x32_bf16 v[44:47], v[84:87], v[100:103], v[44:47]
  v_mfma_f32_16x16x32_bf16 v[48:51], v[88:91], v[96:99], v[48:51]
  v_mfma_f32_16x16x32_bf16 v[52:55], v[88:91], v[100:103], v[52:55]
  v_mfma_f32_16x16x32_bf16 v[56:59], v[92:95], v[96:99], v[56:59]
  v_mfma_f32_16x16x32_bf16 v[60:63], v[92:95], v[100:103], v[60:63]
  ds_read_b64_tr_b16 v[84:85], v111 offset:6144
  ds_read_b64_tr_b16 v[86:87], v111 offset:6912
  ds_read_b64_tr_b16 v[88:89], v112 offset:6144
  ds_read_b64_tr_b16 v[90:91], v112 offset:6912
  ds_read_b64_tr_b16 v[92:93], v113 offset:6144
  ds_read_b64_tr_b16 v[94:95], v113 offset:6912
  ds_read_b128 v[96:99], v110 offset:0
  ds_read_b128 v[100:103], v110 offset:2048
  s_waitcnt lgkmcnt(8)
  v_mfma_f32_16x16x32_bf16 v[40:43], v[64:67], v[76:79], v[40:43]
  v_mfma_f32_16x16x32_bf16 v[44:47], v[64:67], v[80:83], v[44:47]
  v_mfma_f32_16x16x32_bf16 v[48:51], v[68:71], v[76:79], v[48:51]
  v_mfma_f32_16x16x32_bf16 v[52:55], v[68:71], v[80:83], v[52:55]
  v_mfma_f32_16x16x32_bf16 v[56:59], v[72:75], v[76:79], v[56:59]
  v_mfma_f32_16x16x32_bf16 v[60:63], v[72:75], v[80:83], v[60:63]
  s_waitcnt lgkmcnt(0)
  s_barrier
  ds_read_b64_tr_b16 v[64:65], v111 offset:28672
  ds_read_b64_tr_b16 v[66:67], v111 offset:29440
  ds_read_b64_tr_b16 v[68:69], v112 offset:28672
  ds_read_b64_tr_b16 v[70:71], v112 offset:29440
  ds_read_b64_tr_b16 v[72:73], v113 offset:28672
  ds_read_b64_tr_b16 v[74:75], v113 offset:29440
  ds_read_b128 v[76:79], v109 offset:28672
  ds_read_b128 v[80:83], v109 offset:30720
  v_mfma_f32_16x16x32_bf16 v[40:43], v[84:87], v[96:99], v[40:43]
  v_mfma_f32_16x16x32_bf16 v[44:47], v[84:87], v[100:103], v[44:47]
  v_mfma_f32_16x16x32_bf16 v[48:51], v[88:91], v[96:99], v[48:51]
  v_mfma_f32_16x16x32_bf16 v[52:55], v[88:91], v[100:103], v[52:55]
  v_mfma_f32_16x16x32_bf16 v[56:59], v[92:95], v[96:99], v[56:59]
  v_mfma_f32_16x16x32_bf16 v[60:63], v[92:95], v[100:103], v[60:63]
  ds_read_b64_tr_b16 v[84:85], v111 offset:34816
  ds_read_b64_tr_b16 v[86:87], v111 offset:35584
  ds_read_b64_tr_b16 v[88:89], v112 offset:34816
  ds_read_b64_tr_b16 v[90:91], v112 offset:35584
  ds_read_b64_tr_b16 v[92:93], v113 offset:34816
  ds_read_b64_tr_b16 v[94:95], v113 offset:35584
  ds_read_b128 v[96:99], v110 offset:28672
  ds_read_b128 v[100:103], v110 offset:30720
  s_waitcnt lgkmcnt(8)
  v_mfma_f32_16x16x32_bf16 v[40:43], v[64:67], v[76:79], v[40:43]
  v_mfma_f32_16x16x32_bf16 v[44:47], v[64:67], v[80:83], v[44:47]
  v_mfma_f32_16x16x32_bf16 v[48:51], v[68:71], v[76:79], v[48:51]
  v_mfma_f32_16x16x32_bf16 v[52:55], v[68:71], v[80:83], v[52:55]
  v_mfma_f32_16x16x32_bf16 v[56:59], v[72:75], v[76:79], v[56:59]
  v_mfma_f32_16x16x32_bf16 v[60:63], v[72:75], v[80:83], v[60:63]
  s_waitcnt lgkmcnt(0)
  v_mfma_f32_16x16x32_bf16 v[40:43], v[84:87], v[96:99], v[40:43]
  v_mfma_f32_16x16x32_bf16 v[44:47], v[84:87], v[100:103], v[44:47]
  v_mfma_f32_16x16x32_bf16 v[48:51], v[88:91], v[96:99], v[48:51]
  v_mfma_f32_16x16x32_bf16 v[52:55], v[88:91], v[100:103], v[52:55]
  v_mfma_f32_16x16x32_bf16 v[56:59], v[92:95], v[96:99], v[56:59]
  v_mfma_f32_16x16x32_bf16 v[60:63], v[92:95], v[100:103], v[60:63]
  s_nop 7
  s_nop 7
  s_lshl_b32 s48, s25, 5
  v_add_u32 v4, s48, v13
  v_mul_u32_u24 v4, 192, v4
  v_lshl_add_u32 v4, v14, 3, v4
  s_mul_i32 s48, s26, 96
  s_add_u32 s48, s48, 0
  v_add_u32 v4, s48, v4
  v_pk_mul_f32 v[130:131], v[40:41], v[40:41]
  v_pk_mul_f32 v[132:133], v[42:43], v[42:43]
  v_pk_mul_f32 v[134:135], v[44:45], v[44:45]
  v_pk_mul_f32 v[136:137], v[46:47], v[46:47]
  v_pk_fma_f32 v[130:131], v[130:131], v[124:125], v[126:127]
  v_pk_fma_f32 v[132:133], v[132:133], v[124:125], v[126:127]
  v_pk_fma_f32 v[134:135], v[134:135], v[124:125], v[126:127]
  v_pk_fma_f32 v[136:137], v[136:137], v[124:125], v[126:127]
  v_pk_mul_f32 v[130:131], v[130:131], v[40:41]
  v_pk_mul_f32 v[132:133], v[132:133], v[42:43]
  v_pk_mul_f32 v[134:135], v[134:135], v[44:45]
  v_pk_mul_f32 v[136:137], v[136:137], v[46:47]
  v_exp_f32 v130, v130
  v_exp_f32 v131, v131
  v_exp_f32 v132, v132
  v_exp_f32 v133, v133
  v_exp_f32 v134, v134
  v_exp_f32 v135, v135
  v_exp_f32 v136, v136
  v_exp_f32 v137, v137
  s_nop 0
  v_pk_add_f32 v[130:131], v[130:131], v[128:129]
  v_pk_add_f32 v[132:133], v[132:133], v[128:129]
  v_pk_add_f32 v[134:135], v[134:135], v[128:129]
  v_pk_add_f32 v[136:137], v[136:137], v[128:129]
  v_rcp_f32 v130, v130
  v_rcp_f32 v131, v131
  v_rcp_f32 v132, v132
  v_rcp_f32 v133, v133
  v_rcp_f32 v134, v134
  v_rcp_f32 v135, v135
  v_rcp_f32 v136, v136
  v_rcp_f32 v137, v137
  s_nop 0
  v_pk_mul_f32 v[40:41], v[40:41], v[130:131]
  v_pk_mul_f32 v[42:43], v[42:43], v[132:133]
  v_pk_mul_f32 v[44:45], v[44:45], v[134:135]
  v_pk_mul_f32 v[46:47], v[46:47], v[136:137]
  v_cvt_pk_bf16_f32 v40, v40, v41
  v_cvt_pk_bf16_f32 v41, v42, v43
  ds_write_b64 v4, v[40:41] offset:0
  v_cvt_pk_bf16_f32 v44, v44, v45
  v_cvt_pk_bf16_f32 v45, v46, v47
  ds_write_b64 v4, v[44:45] offset:3072
  v_pk_mul_f32 v[130:131], v[48:49], v[48:49]
  v_pk_mul_f32 v[132:133], v[50:51], v[50:51]
  v_pk_mul_f32 v[134:135], v[52:53], v[52:53]
  v_pk_mul_f32 v[136:137], v[54:55], v[54:55]
  v_pk_fma_f32 v[130:131], v[130:131], v[124:125], v[126:127]
  v_pk_fma_f32 v[132:133], v[132:133], v[124:125], v[126:127]
  v_pk_fma_f32 v[134:135], v[134:135], v[124:125], v[126:127]
  v_pk_fma_f32 v[136:137], v[136:137], v[124:125], v[126:127]
  v_pk_mul_f32 v[130:131], v[130:131], v[48:49]
  v_pk_mul_f32 v[132:133], v[132:133], v[50:51]
  v_pk_mul_f32 v[134:135], v[134:135], v[52:53]
  v_pk_mul_f32 v[136:137], v[136:137], v[54:55]
  v_exp_f32 v130, v130
  v_exp_f32 v131, v131
  v_exp_f32 v132, v132
  v_exp_f32 v133, v133
  v_exp_f32 v134, v134
  v_exp_f32 v135, v135
  v_exp_f32 v136, v136
  v_exp_f32 v137, v137
  s_nop 0
  v_pk_add_f32 v[130:131], v[130:131], v[128:129]
  v_pk_add_f32 v[132:133], v[132:133], v[128:129]
  v_pk_add_f32 v[134:135], v[134:135], v[128:129]
  v_pk_add_f32 v[136:137], v[136:137], v[128:129]
  v_rcp_f32 v130, v130
  v_rcp_f32 v131, v131
  v_rcp_f32 v132, v132
  v_rcp_f32 v133, v133
  v_rcp_f32 v134, v134
  v_rcp_f32 v135, v135
  v_rcp_f32 v136, v136
  v_rcp_f32 v137, v137
  s_nop 0
  v_pk_mul_f32 v[48:49], v[48:49], v[130:131]
  v_pk_mul_f32 v[50:51], v[50:51], v[132:133]
  v_pk_mul_f32 v[52:53], v[52:53], v[134:135]
  v_pk_mul_f32 v[54:55], v[54:55], v[136:137]
  v_cvt_pk_bf16_f32 v48, v48, v49
  v_cvt_pk_bf16_f32 v49, v50, v51
  ds_write_b64 v4, v[48:49] offset:32
  v_cvt_pk_bf16_f32 v52, v52, v53
  v_cvt_pk_bf16_f32 v53, v54, v55
  ds_write_b64 v4, v[52:53] offset:3104
  s_cmp_eq_u32 s57, 0
  s_cbranch_scc1 k1z_38
  v_pk_mul_f32 v[130:131], v[56:57], v[56:57]
  v_pk_mul_f32 v[132:133], v[58:59], v[58:59]
  v_pk_mul_f32 v[134:135], v[60:61], v[60:61]
  v_pk_mul_f32 v[136:137], v[62:63], v[62:63]
  v_pk_fma_f32 v[130:131], v[130:131], v[124:125], v[126:127]
  v_pk_fma_f32 v[132:133], v[132:133], v[124:125], v[126:127]
  v_pk_fma_f32 v[134:135], v[134:135], v[124:125], v[126:127]
  v_pk_fma_f32 v[136:137], v[136:137], v[124:125], v[126:127]
  v_pk_mul_f32 v[130:131], v[130:131], v[56:57]
  v_pk_mul_f32 v[132:133], v[132:133], v[58:59]
  v_pk_mul_f32 v[134:135], v[134:135], v[60:61]
  v_pk_mul_f32 v[136:137], v[136:137], v[62:63]
  v_exp_f32 v130, v130
  v_exp_f32 v131, v131
  v_exp_f32 v132, v132
  v_exp_f32 v133, v133
  v_exp_f32 v134, v134
  v_exp_f32 v135, v135
  v_exp_f32 v136, v136
  v_exp_f32 v137, v137
  s_nop 0
  v_pk_add_f32 v[130:131], v[130:131], v[128:129]
  v_pk_add_f32 v[132:133], v[132:133], v[128:129]
  v_pk_add_f32 v[134:135], v[134:135], v[128:129]
  v_pk_add_f32 v[136:137], v[136:137], v[128:129]
  v_rcp_f32 v130, v130
  v_rcp_f32 v131, v131
  v_rcp_f32 v132, v132
  v_rcp_f32 v133, v133
  v_rcp_f32 v134, v134
  v_rcp_f32 v135, v135
  v_rcp_f32 v136, v136
  v_rcp_f32 v137, v137
  s_nop 0
  v_pk_mul_f32 v[56:57], v[56:57], v[130:131]
  v_pk_mul_f32 v[58:59], v[58:59], v[132:133]
  v_pk_mul_f32 v[60:61], v[60:61], v[134:135]
  v_pk_mul_f32 v[62:63], v[62:63], v[136:137]
  v_cvt_pk_bf16_f32 v56, v56, v57
  v_cvt_pk_bf16_f32 v57, v58, v59
  ds_write_b64 v4, v[56:57] offset:64
  v_cvt_pk_bf16_f32 v60, v60, v61
  v_cvt_pk_bf16_f32 v61, v62, v63
  ds_write_b64 v4, v[60:61] offset:3136
k1z_38:
  s_waitcnt lgkmcnt(0)
  s_barrier
  s_lshl_b32 s48, s25, 8
  s_add_u32 s48, s48, 122880
  v_lshlrev_b32 v5, 3, v13
  v_add_u32 v5, s48, v5
  ds_read_b64 v[140:141], v5 offset:0
  ds_read_b64 v[142:143], v5 offset:128
  s_mul_i32 s48, s24, 3072
  v_lshlrev_b32 v6, 4, v1
  v_add_u32 v6, s48, v6
  v_add_u32 v7, 0, v6
  s_mul_i32 s56, s29, 393216
  s_mul_i32 s49, s28, 24576
  s_add_u32 s56, s56, s49
  s_waitcnt lgkmcnt(0)
  v_fma_f32 v16, v16, v140, -v141
  v_fma_f32 v17, v17, v140, -v141
  v_fma_f32 v18, v18, v140, -v141
  v_fma_f32 v19, v19, v140, -v141
  v_cvt_pk_bf16_f32 v16, v16, v17
  v_cvt_pk_bf16_f32 v17, v18, v19
  ds_write_b64 v4, v[16:17] offset:28672
  v_fma_f32 v20, v20, v142, -v143
  v_fma_f32 v21, v21, v142, -v143
  v_fma_f32 v22, v22, v142, -v143
  v_fma_f32 v23, v23, v142, -v143
  v_cvt_pk_bf16_f32 v20, v20, v21
  v_cvt_pk_bf16_f32 v21, v22, v23
  ds_write_b64 v4, v[20:21] offset:31744
  v_fma_f32 v24, v24, v140, -v141
  v_fma_f32 v25, v25, v140, -v141
  v_fma_f32 v26, v26, v140, -v141
  v_fma_f32 v27, v27, v140, -v141
  v_cvt_pk_bf16_f32 v24, v24, v25
  v_cvt_pk_bf16_f32 v25, v26, v27
  ds_write_b64 v4, v[24:25] offset:28704
  v_fma_f32 v28, v28, v142, -v143
  v_fma_f32 v29, v29, v142, -v143
  v_fma_f32 v30, v30, v142, -v143
  v_fma_f32 v31, v31, v142, -v143
  v_cvt_pk_bf16_f32 v28, v28, v29
  v_cvt_pk_bf16_f32 v29, v30, v31
  ds_write_b64 v4, v[28:29] offset:31776
  s_cmp_eq_u32 s57, 0
  s_cbranch_scc1 k1z_39
  v_fma_f32 v32, v32, v140, -v141
  v_fma_f32 v33, v33, v140, -v141
  v_fma_f32 v34, v34, v140, -v141
  v_fma_f32 v35, v35, v140, -v141
  v_cvt_pk_bf16_f32 v32, v32, v33
  v_cvt_pk_bf16_f32 v33, v34, v35
  ds_write_b64 v4, v[32:33] offset:28736
  v_fma_f32 v36, v36, v142, -v143
  v_fma_f32 v37, v37, v142, -v143
  v_fma_f32 v38, v38, v142, -v143
  v_fma_f32 v39, v39, v142, -v143
  v_cvt_pk_bf16_f32 v36, v36, v37
  v_cvt_pk_bf16_f32 v37, v38, v39
  ds_write_b64 v4, v[36:37] offset:31808
k1z_39:
  s_waitcnt lgkmcnt(0)
  s_barrier
  ds_read_b128 v[80:83], v7 offset:28672
  ds_read_b128 v[84:87], v7 offset:29696
  ds_read_b128 v[88:91], v7 offset:30720
  s_waitcnt lgkmcnt(0)
  s_add_u32 s48, s56, 20971520
  buffer_store_dwordx4 v[80:83], v6, s[20:23], s48 offen offset:0
  buffer_store_dwordx4 v[84:87], v6, s[20:23], s48 offen offset:1024
  buffer_store_dwordx4 v[88:91], v6, s[20:23], s48 offen offset:2048
  s_endpgm
k1_load:
  s_sub_u32 s25, s24, 8
  v_lshrrev_b32 v4, 3, v1
  v_and_b32 v5, 7, v1
  v_xor_b32 v5, v5, v4
  v_lshlrev_b32 v5, 4, v5
  v_lshl_add_u32 v2, v4, 10, v5
  s_lshl_b32 s35, s25, 10
  s_cmp_eq_u32 s27, 0
  s_cbranch_scc0 k1_lz
  s_mov_b32 s16, s6
  s_and_b32 s17, s7, 0xffff
  s_mov_b32 s18, 1572864
  s_mov_b32 s19, 0x00020000
  s_and_b32 s48, s25, 1
  s_lshl_b32 s48, s48, 2
  v_lshrrev_b32 v5, 4, v1
  v_and_b32 v5, 1, v5
  v_lshlrev_b32 v5, 1, v5
  v_or_b32 v5, s48, v5
  v_and_b32 v6, 7, v1
  v_xor_b32 v5, v5, v6
  v_lshlrev_b32 v5, 4, v5
  v_mul_u32_u24 v3, 3072, v4
  v_add_u32 v3, v3, v5
  s_mul_i32 s36, s25, 24576
  s_lshl_b32 s48, s29, 7
  s_add_u32 s36, s36, s48
  s_lshl_b32 s48, s28, 17
  s_lshl_b32 s49, s25, 13
  s_add_u32 s32, s48, s49
  s_sub_u32 s32, s32, 16384
  s_cmp_lt_i32 s32, 0
  s_cselect_b32 s33, 0, s32
  s_cmp_lt_u32 s25, 2
  s_cselect_b32 s43, 1, 0
  s_add_u32 m0, s35, 18432
  s_add_u32 s42, s36, 0
  buffer_load_dwordx4 v3, s[16:19], s42 offen lds
  s_add_u32 m0, s35, 22528
  s_add_u32 s42, s36, 98304
  buffer_load_dwordx4 v3, s[16:19], s42 offen lds
  s_add_u32 m0, s35, 26624
  s_add_u32 s42, s36, 1024
  buffer_load_dwordx4 v3, s[16:19], s42 offen lds
  s_add_u32 m0, s35, 30720
  s_add_u32 s42, s36, 99328
  buffer_load_dwordx4 v3, s[16:19], s42 offen lds
  s_add_u32 m0, s35, 34816
  s_add_u32 s42, s36, 2048
  buffer_load_dwordx4 v3, s[16:19], s42 offen lds
  s_add_u32 m0, s35, 38912
  s_add_u32 s42, s36, 100352
  buffer_load_dwordx4 v3, s[16:19], s42 offen lds
  s_add_u32 m0, s35, 0
  s_add_u32 s42, s33, 0
  buffer_load_dwordx4 v2, s[12:15], s42 offen lds
  s_add_u32 m0, s35, 4096
  s_add_u32 s42, s32, 32768
  buffer_load_dwordx4 v2, s[12:15], s42 offen lds
  s_add_u32 m0, s35, 8192
  s_add_u32 s42, s32, 65536
  buffer_load_dwordx4 v2, s[12:15], s42 offen lds
  s_add_u32 m0, s35, 12288
  s_add_u32 s42, s32, 98304
  buffer_load_dwordx4 v2, s[12:15], s42 offen lds
  s_cmp_eq_u32 s43, 0
  s_cbranch_scc1 k1h_40
  s_add_u32 m0, s35, 16384
  s_add_u32 s42, s32, 131072
  buffer_load_dwordx4 v2, s[12:15], s42 offen lds
k1h_40:
  s_add_u32 m0, s35, 61440
  s_add_u32 s42, s36, 196608
  buffer_load_dwordx4 v3, s[16:19], s42 offen lds
  s_add_u32 m0, s35, 65536
  s_add_u32 s42, s36, 294912
  buffer_load_dwordx4 v3, s[16:19], s42 offen lds
  s_add_u32 m0, s35, 69632
  s_add_u32 s42, s36, 197632
  buffer_load_dwordx4 v3, s[16:19], s42 offen lds
  s_add_u32 m0, s35, 73728
  s_add_u32 s42, s36, 295936
  buffer_load_dwordx4 v3, s[16:19], s42 offen lds
  s_add_u32 m0, s35, 77824
  s_add_u32 s42, s36, 198656
  buffer_load_dwordx4 v3, s[16:19], s42 offen lds
  s_add_u32 m0, s35, 81920
  s_add_u32 s42, s36, 296960
  buffer_load_dwordx4 v3, s[16:19], s42 offen lds
  s_add_u32 m0, s35, 43008
  s_add_u32 s42, s33, 128
  buffer_load_dwordx4 v2, s[12:15], s42 offen lds
  s_add_u32 m0, s35, 47104
  s_add_u32 s42, s32, 32896
  buffer_load_dwordx4 v2, s[12:15], s42 offen lds
  s_add_u32 m0, s35, 51200
  s_add_u32 s42, s32, 65664
  buffer_load_dwordx4 v2, s[12:15], s42 offen lds
  s_add_u32 m0, s35, 55296
  s_add_u32 s42, s32, 98432
  buffer_load_dwordx4 v2, s[12:15], s42 offen lds
  s_cmp_eq_u32 s43, 0
  s_cbranch_scc1 k1h_41
  s_add_u32 m0, s35, 59392
  s_add_u32 s42, s32, 131200
  buffer_load_dwordx4 v2, s[12:15], s42 offen lds
k1h_41:
  s_waitcnt vmcnt(10)
  s_barrier
  s_add_u32 m0, s35, 104448
  s_add_u32 s42, s36, 393216
  buffer_load_dwordx4 v3, s[16:19], s42 offen lds
  s_add_u32 m0, s35, 108544
  s_add_u32 s42, s36, 491520
  buffer_load_dwordx4 v3, s[16:19], s42 offen lds
  s_add_u32 m0, s35, 112640
  s_add_u32 s42, s36, 394240
  buffer_load_dwordx4 v3, s[16:19], s42 offen lds
  s_add_u32 m0, s35, 116736
  s_add_u32 s42, s36, 492544
  buffer_load_dwordx4 v3, s[16:19], s42 offen lds
  s_add_u32 m0, s35, 120832
  s_add_u32 s42, s36, 395264
  buffer_load_dwordx4 v3, s[16:19], s42 offen lds
  s_add_u32 m0, s35, 124928
  s_add_u32 s42, s36, 493568
  buffer_load_dwordx4 v3, s[16:19], s42 offen lds
  s_add_u32 m0, s35, 86016
  s_add_u32 s42, s33, 256
  buffer_load_dwordx4 v2, s[12:15], s42 offen lds
  s_add_u32 m0, s35, 90112
  s_add_u32 s42, s32, 33024
  buffer_load_dwordx4 v2, s[12:15], s42 offen lds
  s_add_u32 m0, s35, 94208
  s_add_u32 s42, s32, 65792
  buffer_load_dwordx4 v2, s[12:15], s42 offen lds
  s_add_u32 m0, s35, 98304
  s_add_u32 s42, s32, 98560
  buffer_load_dwordx4 v2, s[12:15], s42 offen lds
  s_cmp_eq_u32 s43, 0
  s_cbranch_scc1 k1h_42
  s_add_u32 m0, s35, 102400
  s_add_u32 s42, s32, 131328
  buffer_load_dwordx4 v2, s[12:15], s42 offen lds
k1h_42:
  s_mov_b32 s52, s10
  s_and_b32 s53, s11, 0xffff
  s_mov_b32 s54, 1024
  s_mov_b32 s55, 0x00020000
  s_lshl_b32 s74, s2, 3
  s_lshl_b32 s49, s25, 1
  s_add_u32 s74, s74, s49
  s_lshl_b32 s49, s74, 10
  v_lshlrev_b32 v8, 4, v1
  buffer_load_dwordx4 v[140:143], v8, s[12:15], s49 offen
  buffer_load_dwordx4 v[148:151], v8, s[12:15], s49 offen offset:1024
  buffer_load_dwordx4 v[144:147], v8, s[52:55], 0 offen
  s_waitcnt vmcnt(13)
  s_barrier
  s_add_u32 m0, s35, 18432
  s_add_u32 s42, s36, 589824
  buffer_load_dwordx4 v3, s[16:19], s42 offen lds
  s_add_u32 m0, s35, 22528
  s_add_u32 s42, s36, 688128
  buffer_load_dwordx4 v3, s[16:19], s42 offen lds
  s_add_u32 m0, s35, 26624
  s_add_u32 s42, s36, 590848
  buffer_load_dwordx4 v3, s[16:19], s42 offen lds
  s_add_u32 m0, s35, 30720
  s_add_u32 s42, s36, 689152
  buffer_load_dwordx4 v3, s[16:19], s42 offen lds
  s_add_u32 m0, s35, 34816
  s_add_u32 s42, s36, 591872
  buffer_load_dwordx4 v3, s[16:19], s42 offen lds
  s_add_u32 m0, s35, 38912
  s_add_u32 s42, s36, 690176
  buffer_load_dwordx4 v3, s[16:19], s42 offen lds
  s_add_u32 m0, s35, 0
  s_add_u32 s42, s33, 384
  buffer_load_dwordx4 v2, s[12:15], s42 offen lds
  s_add_u32 m0, s35, 4096
  s_add_u32 s42, s32, 33152
  buffer_load_dwordx4 v2, s[12:15], s42 offen lds
  s_add_u32 m0, s35, 8192
  s_add_u32 s42, s32, 65920
  buffer_load_dwordx4 v2, s[12:15], s42 offen lds
  s_add_u32 m0, s35, 12288
  s_add_u32 s42, s32, 98688
  buffer_load_dwordx4 v2, s[12:15], s42 offen lds
  s_cmp_eq_u32 s43, 0
  s_cbranch_scc1 k1h_43
  s_add_u32 m0, s35, 16384
  s_add_u32 s42, s32, 131456
  buffer_load_dwordx4 v2, s[12:15], s42 offen lds
k1h_43:
  s_waitcnt vmcnt(13)
  s_barrier
  s_add_u32 m0, s35, 61440
  s_add_u32 s42, s36, 786432
  buffer_load_dwordx4 v3, s[16:19], s42 offen lds
  s_add_u32 m0, s35, 65536
  s_add_u32 s42, s36, 884736
  buffer_load_dwordx4 v3, s[16:19], s42 offen lds
  s_add_u32 m0, s35, 69632
  s_add_u32 s42, s36, 787456
  buffer_load_dwordx4 v3, s[16:19], s42 offen lds
  s_add_u32 m0, s35, 73728
  s_add_u32 s42, s36, 885760
  buffer_load_dwordx4 v3, s[16:19], s42 offen lds
  s_add_u32 m0, s35, 77824
  s_add_u32 s42, s36, 788480
  buffer_load_dwordx4 v3, s[16:19], s42 offen lds
  s_add_u32 m0, s35, 81920
  s_add_u32 s42, s36, 886784
  buffer_load_dwordx4 v3, s[16:19], s42 offen lds
  s_add_u32 m0, s35, 43008
  s_add_u32 s42, s33, 512
  buffer_load_dwordx4 v2, s[12:15], s42 offen lds
  s_add_u32 m0, s35, 47104
  s_add_u32 s42, s32, 33280
  buffer_load_dwordx4 v2, s[12:15], s42 offen lds
  s_add_u32 m0, s35, 51200
  s_add_u32 s42, s32, 66048
  buffer_load_dwordx4 v2, s[12:15], s42 offen lds
  s_add_u32 m0, s35, 55296
  s_add_u32 s42, s32, 98816
  buffer_load_dwordx4 v2, s[12:15], s42 offen lds
  s_cmp_eq_u32 s43, 0
  s_cbranch_scc1 k1h_44
  s_add_u32 m0, s35, 59392
  s_add_u32 s42, s32, 131584
  buffer_load_dwordx4 v2, s[12:15], s42 offen lds
k1h_44:
  s_waitcnt vmcnt(10)
  s_barrier
  s_add_u32 m0, s35, 104448
  s_add_u32 s42, s36, 983040
  buffer_load_dwordx4 v3, s[16:19], s42 offen lds
  s_add_u32 m0, s35, 108544
  s_add_u32 s42, s36, 1081344
  buffer_load_dwordx4 v3, s[16:19], s42 offen lds
  s_add_u32 m0, s35, 112640
  s_add_u32 s42, s36, 984064
  buffer_load_dwordx4 v3, s[16:19], s42 offen lds
  s_add_u32 m0, s35, 116736
  s_add_u32 s42, s36, 1082368
  buffer_load_dwordx4 v3, s[16:19], s42 offen lds
  s_add_u32 m0, s35, 120832
  s_add_u32 s42, s36, 985088
  buffer_load_dwordx4 v3, s[16:19], s42 offen lds
  s_add_u32 m0, s35, 124928
  s_add_u32 s42, s36, 1083392
  buffer_load_dwordx4 v3, s[16:19], s42 offen lds
  s_add_u32 m0, s35, 86016
  s_add_u32 s42, s33, 640
  buffer_load_dwordx4 v2, s[12:15], s42 offen lds
  s_add_u32 m0, s35, 90112
  s_add_u32 s42, s32, 33408
  buffer_load_dwordx4 v2, s[12:15], s42 offen lds
  s_add_u32 m0, s35, 94208
  s_add_u32 s42, s32, 66176
  buffer_load_dwordx4 v2, s[12:15], s42 offen lds
  s_add_u32 m0, s35, 98304
  s_add_u32 s42, s32, 98944
  buffer_load_dwordx4 v2, s[12:15], s42 offen lds
  s_cmp_eq_u32 s43, 0
  s_cbranch_scc1 k1h_45
  s_add_u32 m0, s35, 102400
  s_add_u32 s42, s32, 131712
  buffer_load_dwordx4 v2, s[12:15], s42 offen lds
k1h_45:
  s_waitcnt vmcnt(10)
  s_barrier
  s_add_u32 m0, s35, 18432
  s_add_u32 s42, s36, 1179648
  buffer_load_dwordx4 v3, s[16:19], s42 offen lds
  s_add_u32 m0, s35, 22528
  s_add_u32 s42, s36, 1277952
  buffer_load_dwordx4 v3, s[16:19], s42 offen lds
  s_add_u32 m0, s35, 26624
  s_add_u32 s42, s36, 1180672
  buffer_load_dwordx4 v3, s[16:19], s42 offen lds
  s_add_u32 m0, s35, 30720
  s_add_u32 s42, s36, 1278976
  buffer_load_dwordx4 v3, s[16:19], s42 offen lds
  s_add_u32 m0, s35, 34816
  s_add_u32 s42, s36, 1181696
  buffer_load_dwordx4 v3, s[16:19], s42 offen lds
  s_add_u32 m0, s35, 38912
  s_add_u32 s42, s36, 1280000
  buffer_load_dwordx4 v3, s[16:19], s42 offen lds
  s_add_u32 m0, s35, 0
  s_add_u32 s42, s33, 768
  buffer_load_dwordx4 v2, s[12:15], s42 offen lds
  s_add_u32 m0, s35, 4096
  s_add_u32 s42, s32, 33536
  buffer_load_dwordx4 v2, s[12:15], s42 offen lds
  s_add_u32 m0, s35, 8192
  s_add_u32 s42, s32, 66304
  buffer_load_dwordx4 v2, s[12:15], s42 offen lds
  s_add_u32 m0, s35, 12288
  s_add_u32 s42, s32, 99072
  buffer_load_dwordx4 v2, s[12:15], s42 offen lds
  s_cmp_eq_u32 s43, 0
  s_cbranch_scc1 k1h_46
  s_add_u32 m0, s35, 16384
  s_add_u32 s42, s32, 131840
  buffer_load_dwordx4 v2, s[12:15], s42 offen lds
k1h_46:
  v_mov_b32 v152, 0
  v_dot2c_f32_bf16 v152, v140, v144
  v_dot2c_f32_bf16 v152, v141, v145
  v_dot2c_f32_bf16 v152, v142, v146
  v_dot2c_f32_bf16 v152, v143, v147
  v_mov_b32 v153, 0
  v_dot2c_f32_bf16 v153, v148, v144
  v_dot2c_f32_bf16 v153, v149, v145
  v_dot2c_f32_bf16 v153, v150, v146
  v_dot2c_f32_bf16 v153, v151, v147
  s_nop 3
  v_add_f32_dpp v152, v152, v152 row_ror:8 row_mask:0xf bank_mask:0xf
  v_add_f32_dpp v153, v153, v153 row_ror:8 row_mask:0xf bank_mask:0xf
  s_nop 1
  v_add_f32_dpp v152, v152, v152 row_ror:4 row_mask:0xf bank_mask:0xf
  v_add_f32_dpp v153, v153, v153 row_ror:4 row_mask:0xf bank_mask:0xf
  s_nop 1
  v_add_f32_dpp v152, v152, v152 row_ror:2 row_mask:0xf bank_mask:0xf
  v_add_f32_dpp v153, v153, v153 row_ror:2 row_mask:0xf bank_mask:0xf
  s_nop 1
  v_add_f32_dpp v152, v152, v152 row_ror:1 row_mask:0xf bank_mask:0xf
  v_add_f32_dpp v153, v153, v153 row_ror:1 row_mask:0xf bank_mask:0xf
  s_nop 1
  v_readlane_b32 s70, v152, 0
  v_readlane_b32 s71, v152, 16
  v_readlane_b32 s72, v152, 32
  v_readlane_b32 s73, v152, 48
  s_nop 1
  v_mov_b32 v154, s70
  v_add_f32 v154, s71, v154
  v_add_f32 v154, s72, v154
  v_add_f32 v154, s73, v154
  v_mul_f32 v154, 0xbfb8aa3b, v154
  v_exp_f32 v154, v154
  s_nop 0
  v_add_f32 v154, 1.0, v154
  v_rcp_f32 v154, v154
  v_readlane_b32 s70, v153, 0
  v_readlane_b32 s71, v153, 16
  v_readlane_b32 s72, v153, 32
  v_readlane_b32 s73, v153, 48
  s_nop 1
  v_mov_b32 v155, s70
  v_add_f32 v155, s71, v155
  v_add_f32 v155, s72, v155
  v_add_f32 v155, s73, v155
  v_mul_f32 v155, 0xbfb8aa3b, v155
  v_exp_f32 v155, v155
  s_nop 0
  v_add_f32 v155, 1.0, v155
  v_rcp_f32 v155, v155
  s_lshl_b32 s48, s74, 2
  s_add_u32 s48, s48, 17825792
  v_mov_b32 v9, 0
  s_mov_b64 exec, 1
  buffer_store_dwordx2 v[154:155], v9, s[20:23], s48 offen
  s_mov_b64 exec, -1
  s_waitcnt vmcnt(11)
  s_barrier
  s_add_u32 m0, s35, 61440
  s_add_u32 s42, s36, 1376256
  buffer_load_dwordx4 v3, s[16:19], s42 offen lds
  s_add_u32 m0, s35, 65536
  s_add_u32 s42, s36, 1474560
  buffer_load_dwordx4 v3, s[16:19], s42 offen lds
  s_add_u32 m0, s35, 69632
  s_add_u32 s42, s36, 1377280
  buffer_load_dwordx4 v3, s[16:19], s42 offen lds
  s_add_u32 m0, s35, 73728
  s_add_u32 s42, s36, 1475584
  buffer_load_dwordx4 v3, s[16:19], s42 offen lds
  s_add_u32 m0, s35, 77824
  s_add_u32 s42, s36, 1378304
  buffer_load_dwordx4 v3, s[16:19], s42 offen lds
  s_add_u32 m0, s35, 81920
  s_add_u32 s42, s36, 1476608
  buffer_load_dwordx4 v3, s[16:19], s42 offen lds
  s_add_u32 m0, s35, 43008
  s_add_u32 s42, s33, 896
  buffer_load_dwordx4 v2, s[12:15], s42 offen lds
  s_add_u32 m0, s35, 47104
  s_add_u32 s42, s32, 33664
  buffer_load_dwordx4 v2, s[12:15], s42 offen lds
  s_add_u32 m0, s35, 51200
  s_add_u32 s42, s32, 66432
  buffer_load_dwordx4 v2, s[12:15], s42 offen lds
  s_add_u32 m0, s35, 55296
  s_add_u32 s42, s32, 99200
  buffer_load_dwordx4 v2, s[12:15], s42 offen lds
  s_cmp_eq_u32 s43, 0
  s_cbranch_scc1 k1h_47
  s_add_u32 m0, s35, 59392
  s_add_u32 s42, s32, 131968
  buffer_load_dwordx4 v2, s[12:15], s42 offen lds
k1h_47:
  s_waitcnt vmcnt(11)
  s_barrier
  s_waitcnt vmcnt(0)
  s_barrier
  s_endpgm
k1_lz:
  s_mov_b32 s16, s8
  s_and_b32 s17, s9, 0xffff
  s_mov_b32 s18, 1409024
  s_mov_b32 s19, 0x00020000
  v_add_u32 v6, 0, v1
  v_mul_u32_u24 v3, 0x5556, v6
  v_lshrrev_b32 v3, 18, v3
  v_mul_u32_u24 v4, 12, v3
  v_sub_u32 v4, v6, v4
  v_bfe_u32 v5, v3, 3, 1
  v_lshlrev_b32 v5, 1, v5
  v_xor_b32 v4, v4, v5
  s_movk_i32 s48, 2752
  v_mul_lo_u32 v3, v3, s48
  v_lshl_add_u32 v20, v4, 4, v3
  v_add_u32 v6, 64, v1
  v_mul_u32_u24 v3, 0x5556, v6
  v_lshrrev_b32 v3, 18, v3
  v_mul_u32_u24 v4, 12, v3
  v_sub_u32 v4, v6, v4
  v_bfe_u32 v5, v3, 3, 1
  v_lshlrev_b32 v5, 1, v5
  v_xor_b32 v4, v4, v5
  s_movk_i32 s48, 2752
  v_mul_lo_u32 v3, v3, s48
  v_lshl_add_u32 v21, v4, 4, v3
  v_add_u32 v6, 128, v1
  v_mul_u32_u24 v3, 0x5556, v6
  v_lshrrev_b32 v3, 18, v3
  v_mul_u32_u24 v4, 12, v3
  v_sub_u32 v4, v6, v4
  v_bfe_u32 v5, v3, 3, 1
  v_lshlrev_b32 v5, 1, v5
  v_xor_b32 v4, v4, v5
  s_movk_i32 s48, 2752
  v_mul_lo_u32 v3, v3, s48
  v_lshl_add_u32 v22, v4, 4, v3
  s_mul_i32 s30, s29, 5
  s_min_u32 s48, s29, 3
  s_add_u32 s30, s30, s48
  s_lshl_b32 s48, s30, 5
  s_mul_i32 s49, s25, 44032
  s_add_u32 s36, s48, s49
  s_mul_i32 s37, s25, 3072
  s_add_u32 s37, s37, 16384
  s_lshl_b32 s48, s28, 17
  s_lshl_b32 s49, s25, 13
  s_add_u32 s32, s48, s49
  s_mov_b32 s64, s60
  s_and_b32 s65, s61, 0xffff
  s_mov_b32 s66, 256
  s_mov_b32 s67, 0x00020000
  v_subrev_u32 v24, 512, v0
  s_lshl_b32 s48, s28, 7
  v_add_u32 v25, s48, v24
  v_lshlrev_b32 v25, 4, v25
  s_memrealtime s[90:91]
  s_waitcnt lgkmcnt(0)
  s_or_b32 s54, s90, 1
  v_mov_b32 v158, s54
  v_mov_b32 v159, 0
  v_mov_b32 v157, 0
  s_add_u32 m0, s37, 0
  s_add_u32 s42, s36, 1376
  buffer_load_dwordx4 v20, s[16:19], s42 offen lds
  s_add_u32 m0, s37, 1024
  s_add_u32 s42, s36, 1376
  buffer_load_dwordx4 v21, s[16:19], s42 offen lds
  s_add_u32 m0, s37, 2048
  s_add_u32 s42, s36, 1376
  buffer_load_dwordx4 v22, s[16:19], s42 offen lds
  s_add_u32 m0, s35, 0
  s_add_u32 s42, s32, 0
  buffer_load_dwordx4 v2, s[12:15], s42 offen lds
  s_add_u32 m0, s35, 4096
  s_add_u32 s42, s32, 32768
  buffer_load_dwordx4 v2, s[12:15], s42 offen lds
  s_add_u32 m0, s35, 8192
  s_add_u32 s42, s32, 65536
  buffer_load_dwordx4 v2, s[12:15], s42 offen lds
  s_add_u32 m0, s35, 12288
  s_add_u32 s42, s32, 98304
  buffer_load_dwordx4 v2, s[12:15], s42 offen lds
  s_add_u32 m0, s37, 28672
  s_add_u32 s42, s36, 177504
  buffer_load_dwordx4 v20, s[16:19], s42 offen lds
  s_add_u32 m0, s37, 29696
  s_add_u32 s42, s36, 177504
  buffer_load_dwordx4 v21, s[16:19], s42 offen lds
  s_add_u32 m0, s37, 30720
  s_add_u32 s42, s36, 177504
  buffer_load_dwordx4 v22, s[16:19], s42 offen lds
  s_add_u32 m0, s35, 28672
  s_add_u32 s42, s32, 128
  buffer_load_dwordx4 v2, s[12:15], s42 offen lds
  s_add_u32 m0, s35, 32768
  s_add_u32 s42, s32, 32896
  buffer_load_dwordx4 v2, s[12:15], s42 offen lds
  s_add_u32 m0, s35, 36864
  s_add_u32 s42, s32, 65664
  buffer_load_dwordx4 v2, s[12:15], s42 offen lds
  s_add_u32 m0, s35, 40960
  s_add_u32 s42, s32, 98432
  buffer_load_dwordx4 v2, s[12:15], s42 offen lds
  s_waitcnt vmcnt(7)
  s_barrier
  s_add_u32 m0, s37, 57344
  s_add_u32 s42, s36, 353632
  buffer_load_dwordx4 v20, s[16:19], s42 offen lds
  s_add_u32 m0, s37, 58368
  s_add_u32 s42, s36, 353632
  buffer_load_dwordx4 v21, s[16:19], s42 offen lds
  s_add_u32 m0, s37, 59392
  s_add_u32 s42, s36, 353632
  buffer_load_dwordx4 v22, s[16:19], s42 offen lds
  s_add_u32 m0, s35, 57344
  s_add_u32 s42, s32, 256
  buffer_load_dwordx4 v2, s[12:15], s42 offen lds
  s_add_u32 m0, s35, 61440
  s_add_u32 s42, s32, 33024
  buffer_load_dwordx4 v2, s[12:15], s42 offen lds
  s_add_u32 m0, s35, 65536
  s_add_u32 s42, s32, 65792
  buffer_load_dwordx4 v2, s[12:15], s42 offen lds
  s_add_u32 m0, s35, 69632
  s_add_u32 s42, s32, 98560
  buffer_load_dwordx4 v2, s[12:15], s42 offen lds
  s_add_u32 m0, s37, 86016
  s_add_u32 s42, s36, 529760
  buffer_load_dwordx4 v20, s[16:19], s42 offen lds
  s_add_u32 m0, s37, 87040
  s_add_u32 s42, s36, 529760
  buffer_load_dwordx4 v21, s[16:19], s42 offen lds
  s_add_u32 m0, s37, 88064
  s_add_u32 s42, s36, 529760
  buffer_load_dwordx4 v22, s[16:19], s42 offen lds
  s_add_u32 m0, s35, 86016
  s_add_u32 s42, s32, 384
  buffer_load_dwordx4 v2, s[12:15], s42 offen lds
  s_add_u32 m0, s35, 90112
  s_add_u32 s42, s32, 33152
  buffer_load_dwordx4 v2, s[12:15], s42 offen lds
  s_add_u32 m0, s35, 94208
  s_add_u32 s42, s32, 65920
  buffer_load_dwordx4 v2, s[12:15], s42 offen lds
  s_add_u32 m0, s35, 98304
  s_add_u32 s42, s32, 98688
  buffer_load_dwordx4 v2, s[12:15], s42 offen lds
  s_mov_b32 s52, s10
  s_and_b32 s53, s11, 0xffff
  s_mov_b32 s54, 1024
  s_mov_b32 s55, 0x00020000
  s_lshl_b32 s74, s2, 3
  s_lshl_b32 s49, s25, 1
  s_add_u32 s74, s74, s49
  s_lshl_b32 s49, s74, 10
  v_lshlrev_b32 v8, 4, v1
  buffer_load_dwordx4 v[140:143], v8, s[12:15], s49 offen
  buffer_load_dwordx4 v[148:151], v8, s[12:15], s49 offen offset:1024
  buffer_load_dwordx4 v[144:147], v8, s[52:55], 0 offen
  s_waitcnt vmcnt(17)
  s_barrier
  s_add_u32 m0, s37, 0
  s_add_u32 s42, s36, 705888
  buffer_load_dwordx4 v20, s[16:19], s42 offen lds
  s_add_u32 m0, s37, 1024
  s_add_u32 s42, s36, 705888
  buffer_load_dwordx4 v21, s[16:19], s42 offen lds
  s_add_u32 m0, s37, 2048
  s_add_u32 s42, s36, 705888
  buffer_load_dwordx4 v22, s[16:19], s42 offen lds
  s_add_u32 m0, s35, 0
  s_add_u32 s42, s32, 512
  buffer_load_dwordx4 v2, s[12:15], s42 offen lds
  s_add_u32 m0, s35, 4096
  s_add_u32 s42, s32, 33280
  buffer_load_dwordx4 v2, s[12:15], s42 offen lds
  s_add_u32 m0, s35, 8192
  s_add_u32 s42, s32, 66048
  buffer_load_dwordx4 v2, s[12:15], s42 offen lds
  s_add_u32 m0, s35, 12288
  s_add_u32 s42, s32, 98816
  buffer_load_dwordx4 v2, s[12:15], s42 offen lds
  s_waitcnt vmcnt(17)
  s_barrier
  s_add_u32 m0, s37, 28672
  s_add_u32 s42, s36, 882016
  buffer_load_dwordx4 v20, s[16:19], s42 offen lds
  s_add_u32 m0, s37, 29696
  s_add_u32 s42, s36, 882016
  buffer_load_dwordx4 v21, s[16:19], s42 offen lds
  s_add_u32 m0, s37, 30720
  s_add_u32 s42, s36, 882016
  buffer_load_dwordx4 v22, s[16:19], s42 offen lds
  s_add_u32 m0, s35, 28672
  s_add_u32 s42, s32, 640
  buffer_load_dwordx4 v2, s[12:15], s42 offen lds
  s_add_u32 m0, s35, 32768
  s_add_u32 s42, s32, 33408
  buffer_load_dwordx4 v2, s[12:15], s42 offen lds
  s_add_u32 m0, s35, 36864
  s_add_u32 s42, s32, 66176
  buffer_load_dwordx4 v2, s[12:15], s42 offen lds
  s_add_u32 m0, s35, 40960
  s_add_u32 s42, s32, 98944
  buffer_load_dwordx4 v2, s[12:15], s42 offen lds
  s_waitcnt vmcnt(17)
  s_barrier
  s_add_u32 m0, s37, 57344
  s_add_u32 s42, s36, 1058144
  buffer_load_dwordx4 v20, s[16:19], s42 offen lds
  s_add_u32 m0, s37, 58368
  s_add_u32 s42, s36, 1058144
  buffer_load_dwordx4 v21, s[16:19], s42 offen lds
  s_add_u32 m0, s37, 59392
  s_add_u32 s42, s36, 1058144
  buffer_load_dwordx4 v22, s[16:19], s42 offen lds
  s_add_u32 m0, s35, 57344
  s_add_u32 s42, s32, 768
  buffer_load_dwordx4 v2, s[12:15], s42 offen lds
  s_add_u32 m0, s35, 61440
  s_add_u32 s42, s32, 33536
  buffer_load_dwordx4 v2, s[12:15], s42 offen lds
  s_add_u32 m0, s35, 65536
  s_add_u32 s42, s32, 66304
  buffer_load_dwordx4 v2, s[12:15], s42 offen lds
  s_add_u32 m0, s35, 69632
  s_add_u32 s42, s32, 99072
  buffer_load_dwordx4 v2, s[12:15], s42 offen lds
  s_waitcnt vmcnt(14)
  s_barrier
  s_add_u32 m0, s37, 86016
  s_add_u32 s42, s36, 1234272
  buffer_load_dwordx4 v20, s[16:19], s42 offen lds
  s_add_u32 m0, s37, 87040
  s_add_u32 s42, s36, 1234272
  buffer_load_dwordx4 v21, s[16:19], s42 offen lds
  s_add_u32 m0, s37, 88064
  s_add_u32 s42, s36, 1234272
  buffer_load_dwordx4 v22, s[16:19], s42 offen lds
  s_add_u32 m0, s35, 86016
  s_add_u32 s42, s32, 896
  buffer_load_dwordx4 v2, s[12:15], s42 offen lds
  s_add_u32 m0, s35, 90112
  s_add_u32 s42, s32, 33664
  buffer_load_dwordx4 v2, s[12:15], s42 offen lds
  s_add_u32 m0, s35, 94208
  s_add_u32 s42, s32, 66432
  buffer_load_dwordx4 v2, s[12:15], s42 offen lds
  s_add_u32 m0, s35, 98304
  s_add_u32 s42, s32, 99200
  buffer_load_dwordx4 v2, s[12:15], s42 offen lds
  s_waitcnt vmcnt(14)
  s_barrier
  s_add_u32 m0, s37, 0
  s_add_u32 s42, s36, 0
  buffer_load_dwordx4 v20, s[16:19], s42 offen lds
  s_add_u32 m0, s37, 1024
  s_add_u32 s42, s36, 0
  buffer_load_dwordx4 v21, s[16:19], s42 offen lds
  s_add_u32 m0, s37, 2048
  s_add_u32 s42, s36, 0
  buffer_load_dwordx4 v22, s[16:19], s42 offen lds
  s_add_u32 m0, s35, 0
  s_add_u32 s42, s32, 0
  buffer_load_dwordx4 v2, s[12:15], s42 offen lds
  s_add_u32 m0, s35, 4096
  s_add_u32 s42, s32, 32768
  buffer_load_dwordx4 v2, s[12:15], s42 offen lds
  s_add_u32 m0, s35, 8192
  s_add_u32 s42, s32, 65536
  buffer_load_dwordx4 v2, s[12:15], s42 offen lds
  s_add_u32 m0, s35, 12288
  s_add_u32 s42, s32, 98304
  buffer_load_dwordx4 v2, s[12:15], s42 offen lds
  v_mov_b32 v152, 0
  v_dot2c_f32_bf16 v152, v140, v144
  v_dot2c_f32_bf16 v152, v141, v145
  v_dot2c_f32_bf16 v152, v142, v146
  v_dot2c_f32_bf16 v152, v143, v147
  v_mov_b32 v153, 0
  v_dot2c_f32_bf16 v153, v148, v144
  v_dot2c_f32_bf16 v153, v149, v145
  v_dot2c_f32_bf16 v153, v150, v146
  v_dot2c_f32_bf16 v153, v151, v147
  s_nop 3
  v_add_f32_dpp v152, v152, v152 row_ror:8 row_mask:0xf bank_mask:0xf
  v_add_f32_dpp v153, v153, v153 row_ror:8 row_mask:0xf bank_mask:0xf
  s_nop 1
  v_add_f32_dpp v152, v152, v152 row_ror:4 row_mask:0xf bank_mask:0xf
  v_add_f32_dpp v153, v153, v153 row_ror:4 row_mask:0xf bank_mask:0xf
  s_nop 1
  v_add_f32_dpp v152, v152, v152 row_ror:2 row_mask:0xf bank_mask:0xf
  v_add_f32_dpp v153, v153, v153 row_ror:2 row_mask:0xf bank_mask:0xf
  s_nop 1
  v_add_f32_dpp v152, v152, v152 row_ror:1 row_mask:0xf bank_mask:0xf
  v_add_f32_dpp v153, v153, v153 row_ror:1 row_mask:0xf bank_mask:0xf
  s_nop 1
  v_readlane_b32 s70, v152, 0
  v_readlane_b32 s71, v152, 16
  v_readlane_b32 s72, v152, 32
  v_readlane_b32 s73, v152, 48
  s_nop 1
  v_mov_b32 v154, s70
  v_add_f32 v154, s71, v154
  v_add_f32 v154, s72, v154
  v_add_f32 v154, s73, v154
  v_mul_f32 v154, 0xbfb8aa3b, v154
  v_exp_f32 v154, v154
  s_nop 0
  v_add_f32 v154, 1.0, v154
  v_rcp_f32 v154, v154
  v_readlane_b32 s70, v153, 0
  v_readlane_b32 s71, v153, 16
  v_readlane_b32 s72, v153, 32
  v_readlane_b32 s73, v153, 48
  s_nop 1
  v_mov_b32 v155, s70
  v_add_f32 v155, s71, v155
  v_add_f32 v155, s72, v155
  v_add_f32 v155, s73, v155
  v_mul_f32 v155, 0xbfb8aa3b, v155
  v_exp_f32 v155, v155
  s_nop 0
  v_add_f32 v155, 1.0, v155
  v_rcp_f32 v155, v155
  s_lshl_b32 s48, s74, 2
  s_add_u32 s48, s48, 17825792
  v_mov_b32 v9, 0
  s_mov_b64 exec, 1
  buffer_store_dwordx2 v[154:155], v9, s[20:23], s48 offen
  s_mov_b64 exec, -1
  s_waitcnt vmcnt(15)
  s_barrier
  s_add_u32 m0, s37, 28672
  s_add_u32 s42, s36, 176128
  buffer_load_dwordx4 v20, s[16:19], s42 offen lds
  s_add_u32 m0, s37, 29696
  s_add_u32 s42, s36, 176128
  buffer_load_dwordx4 v21, s[16:19], s42 offen lds
  s_add_u32 m0, s37, 30720
  s_add_u32 s42, s36, 176128
  buffer_load_dwordx4 v22, s[16:19], s42 offen lds
  s_add_u32 m0, s35, 28672
  s_add_u32 s42, s32, 128
  buffer_load_dwordx4 v2, s[12:15], s42 offen lds
  s_add_u32 m0, s35, 32768
  s_add_u32 s42, s32, 32896
  buffer_load_dwordx4 v2, s[12:15], s42 offen lds
  s_add_u32 m0, s35, 36864
  s_add_u32 s42, s32, 65664
  buffer_load_dwordx4 v2, s[12:15], s42 offen lds
  s_add_u32 m0, s35, 40960
  s_add_u32 s42, s32, 98432
  buffer_load_dwordx4 v2, s[12:15], s42 offen lds
  s_waitcnt vmcnt(15)
  s_barrier
  s_add_u32 m0, s37, 57344
  s_add_u32 s42, s36, 352256
  buffer_load_dwordx4 v20, s[16:19], s42 offen lds
  s_add_u32 m0, s37, 58368
  s_add_u32 s42, s36, 352256
  buffer_load_dwordx4 v21, s[16:19], s42 offen lds
  s_add_u32 m0, s37, 59392
  s_add_u32 s42, s36, 352256
  buffer_load_dwordx4 v22, s[16:19], s42 offen lds
  s_add_u32 m0, s35, 57344
  s_add_u32 s42, s32, 256
  buffer_load_dwordx4 v2, s[12:15], s42 offen lds
  s_add_u32 m0, s35, 61440
  s_add_u32 s42, s32, 33024
  buffer_load_dwordx4 v2, s[12:15], s42 offen lds
  s_add_u32 m0, s35, 65536
  s_add_u32 s42, s32, 65792
  buffer_load_dwordx4 v2, s[12:15], s42 offen lds
  s_add_u32 m0, s35, 69632
  s_add_u32 s42, s32, 98560
  buffer_load_dwordx4 v2, s[12:15], s42 offen lds
  s_waitcnt vmcnt(15)
  s_barrier
  s_add_u32 m0, s37, 86016
  s_add_u32 s42, s36, 528384
  buffer_load_dwordx4 v20, s[16:19], s42 offen lds
  s_add_u32 m0, s37, 87040
  s_add_u32 s42, s36, 528384
  buffer_load_dwordx4 v21, s[16:19], s42 offen lds
  s_add_u32 m0, s37, 88064
  s_add_u32 s42, s36, 528384
  buffer_load_dwordx4 v22, s[16:19], s42 offen lds
  s_add_u32 m0, s35, 86016
  s_add_u32 s42, s32, 384
  buffer_load_dwordx4 v2, s[12:15], s42 offen lds
  s_add_u32 m0, s35, 90112
  s_add_u32 s42, s32, 33152
  buffer_load_dwordx4 v2, s[12:15], s42 offen lds
  s_add_u32 m0, s35, 94208
  s_add_u32 s42, s32, 65920
  buffer_load_dwordx4 v2, s[12:15], s42 offen lds
  s_add_u32 m0, s35, 98304
  s_add_u32 s42, s32, 98688
  buffer_load_dwordx4 v2, s[12:15], s42 offen lds
  s_barrier
  v_mov_b32 v6, 123904
  ds_read_b32 v158, v6
  s_waitcnt lgkmcnt(0)
  s_waitcnt vmcnt(14)
  s_barrier
  s_add_u32 m0, s37, 0
  s_add_u32 s42, s36, 704512
  buffer_load_dwordx4 v20, s[16:19], s42 offen lds
  s_add_u32 m0, s37, 1024
  s_add_u32 s42, s36, 704512
  buffer_load_dwordx4 v21, s[16:19], s42 offen lds
  s_add_u32 m0, s37, 2048
  s_add_u32 s42, s36, 704512
  buffer_load_dwordx4 v22, s[16:19], s42 offen lds
  s_add_u32 m0, s35, 0
  s_add_u32 s42, s32, 512
  buffer_load_dwordx4 v2, s[12:15], s42 offen lds
  s_add_u32 m0, s35, 4096
  s_add_u32 s42, s32, 33280
  buffer_load_dwordx4 v2, s[12:15], s42 offen lds
  s_add_u32 m0, s35, 8192
  s_add_u32 s42, s32, 66048
  buffer_load_dwordx4 v2, s[12:15], s42 offen lds
  s_add_u32 m0, s35, 12288
  s_add_u32 s42, s32, 98816
  buffer_load_dwordx4 v2, s[12:15], s42 offen lds
  s_waitcnt vmcnt(14)
  s_barrier
  s_add_u32 m0, s37, 28672
  s_add_u32 s42, s36, 880640
  buffer_load_dwordx4 v20, s[16:19], s42 offen lds
  s_add_u32 m0, s37, 29696
  s_add_u32 s42, s36, 880640
  buffer_load_dwordx4 v21, s[16:19], s42 offen lds
  s_add_u32 m0, s37, 30720
  s_add_u32 s42, s36, 880640
  buffer_load_dwordx4 v22, s[16:19], s42 offen lds
  s_add_u32 m0, s35, 28672
  s_add_u32 s42, s32, 640
  buffer_load_dwordx4 v2, s[12:15], s42 offen lds
  s_add_u32 m0, s35, 32768
  s_add_u32 s42, s32, 33408
  buffer_load_dwordx4 v2, s[12:15], s42 offen lds
  s_add_u32 m0, s35, 36864
  s_add_u32 s42, s32, 66176
  buffer_load_dwordx4 v2, s[12:15], s42 offen lds
  s_add_u32 m0, s35, 40960
  s_add_u32 s42, s32, 98944
  buffer_load_dwordx4 v2, s[12:15], s42 offen lds
  s_waitcnt vmcnt(14)
  s_barrier
  s_add_u32 m0, s37, 57344
  s_add_u32 s42, s36, 1056768
  buffer_load_dwordx4 v20, s[16:19], s42 offen lds
  s_add_u32 m0, s37, 58368
  s_add_u32 s42, s36, 1056768
  buffer_load_dwordx4 v21, s[16:19], s42 offen lds
  s_add_u32 m0, s37, 59392
  s_add_u32 s42, s36, 1056768
  buffer_load_dwordx4 v22, s[16:19], s42 offen lds
  s_add_u32 m0, s35, 57344
  s_add_u32 s42, s32, 768
  buffer_load_dwordx4 v2, s[12:15], s42 offen lds
  s_add_u32 m0, s35, 61440
  s_add_u32 s42, s32, 33536
  buffer_load_dwordx4 v2, s[12:15], s42 offen lds
  s_add_u32 m0, s35, 65536
  s_add_u32 s42, s32, 66304
  buffer_load_dwordx4 v2, s[12:15], s42 offen lds
  s_add_u32 m0, s35, 69632
  s_add_u32 s42, s32, 99072
  buffer_load_dwordx4 v2, s[12:15], s42 offen lds
  s_waitcnt vmcnt(14)
  s_barrier
  s_add_u32 m0, s37, 86016
  s_add_u32 s42, s36, 1232896
  buffer_load_dwordx4 v20, s[16:19], s42 offen lds
  s_add_u32 m0, s37, 87040
  s_add_u32 s42, s36, 1232896
  buffer_load_dwordx4 v21, s[16:19], s42 offen lds
  s_add_u32 m0, s37, 88064
  s_add_u32 s42, s36, 1232896
  buffer_load_dwordx4 v22, s[16:19], s42 offen lds
  s_add_u32 m0, s35, 86016
  s_add_u32 s42, s32, 896
  buffer_load_dwordx4 v2, s[12:15], s42 offen lds
  s_add_u32 m0, s35, 90112
  s_add_u32 s42, s32, 33664
  buffer_load_dwordx4 v2, s[12:15], s42 offen lds
  s_add_u32 m0, s35, 94208
  s_add_u32 s42, s32, 66432
  buffer_load_dwordx4 v2, s[12:15], s42 offen lds
  s_add_u32 m0, s35, 98304
  s_add_u32 s42, s32, 99200
  buffer_load_dwordx4 v2, s[12:15], s42 offen lds
  s_waitcnt vmcnt(14)
  s_barrier
  s_waitcnt vmcnt(7)
  s_barrier
  s_cmp_ge_u32 s25, 2
  s_cbranch_scc1 k1p_48
  s_mov_b32 s48, 16777216
  buffer_load_dwordx4 v[64:67], v25, s[20:23], s48 offen sc0 sc1
  s_mov_b32 s48, 16809984
  buffer_load_dwordx4 v[68:71], v25, s[20:23], s48 offen sc0 sc1
  s_mov_b32 s48, 16842752
  buffer_load_dwordx4 v[72:75], v25, s[20:23], s48 offen sc0 sc1
  s_mov_b32 s48, 16875520
  buffer_load_dwordx4 v[76:79], v25, s[20:23], s48 offen sc0 sc1
  s_mov_b32 s48, 16908288
  buffer_load_dwordx4 v[80:83], v25, s[20:23], s48 offen sc0 sc1
  s_mov_b32 s48, 16941056
  buffer_load_dwordx4 v[84:87], v25, s[20:23], s48 offen sc0 sc1
  s_mov_b32 s48, 16973824
  buffer_load_dwordx4 v[88:91], v25, s[20:23], s48 offen sc0 sc1
  s_mov_b32 s48, 17006592
  buffer_load_dwordx4 v[92:95], v25, s[20:23], s48 offen sc0 sc1
k1p_48:
  s_cmp_ge_u32 s25, 2
  s_cbranch_scc1 k1p_49
  s_waitcnt vmcnt(8)
  s_branch k1p_50
k1p_49:
  s_waitcnt vmcnt(0)
k1p_50:
  s_barrier
  s_cmp_ge_u32 s25, 2
  s_cbranch_scc1 k1p_51
  v_readfirstlane_b32 s54, v158
  s_mov_b32 s52, 0
k1_poll:
  s_waitcnt vmcnt(0)
  v_xor_b32 v5, s54, v65
  v_xor_b32 v6, s54, v67
  v_or_b32 v5, v5, v6
  v_xor_b32 v6, s54, v69
  v_or_b32 v5, v5, v6
  v_xor_b32 v6, s54, v71
  v_or_b32 v5, v5, v6
  v_xor_b32 v6, s54, v73
  v_or_b32 v5, v5, v6
  v_xor_b32 v6, s54, v75
  v_or_b32 v5, v5, v6
  v_xor_b32 v6, s54, v77
  v_or_b32 v5, v5, v6
  v_xor_b32 v6, s54, v79
  v_or_b32 v5, v5, v6
  v_xor_b32 v6, s54, v81
  v_or_b32 v5, v5, v6
  v_xor_b32 v6, s54, v83
  v_or_b32 v5, v5, v6
  v_xor_b32 v6, s54, v85
  v_or_b32 v5, v5, v6
  v_xor_b32 v6, s54, v87
  v_or_b32 v5, v5, v6
  v_xor_b32 v6, s54, v89
  v_or_b32 v5, v5, v6
  v_xor_b32 v6, s54, v91
  v_or_b32 v5, v5, v6
  v_xor_b32 v6, s54, v93
  v_or_b32 v5, v5, v6
  v_xor_b32 v6, s54, v95
  v_or_b32 v5, v5, v6
  v_cmp_ne_u32 vcc, 0, v5
  s_add_u32 s52, s52, 1
  s_cbranch_vccz k1_got
  s_cmp_lt_u32 s52, 0x40000
  s_cbranch_scc0 k1_got
  s_sleep 2
  s_mov_b32 s48, 16777216
  buffer_load_dwordx4 v[64:67], v25, s[20:23], s48 offen sc0 sc1
  s_mov_b32 s48, 16809984
  buffer_load_dwordx4 v[68:71], v25, s[20:23], s48 offen sc0 sc1
  s_mov_b32 s48, 16842752
  buffer_load_dwordx4 v[72:75], v25, s[20:23], s48 offen sc0 sc1
  s_mov_b32 s48, 16875520
  buffer_load_dwordx4 v[76:79], v25, s[20:23], s48 offen sc0 sc1
  s_mov_b32 s48, 16908288
  buffer_load_dwordx4 v[80:83], v25, s[20:23], s48 offen sc0 sc1
  s_mov_b32 s48, 16941056
  buffer_load_dwordx4 v[84:87], v25, s[20:23], s48 offen sc0 sc1
  s_mov_b32 s48, 16973824
  buffer_load_dwordx4 v[88:91], v25, s[20:23], s48 offen sc0 sc1
  s_mov_b32 s48, 17006592
  buffer_load_dwordx4 v[92:95], v25, s[20:23], s48 offen sc0 sc1
  s_branch k1_poll
k1_got:
  v_add_f32 v64, v64, v68
  v_add_f32 v66, v66, v70
  v_add_f32 v64, v64, v72
  v_add_f32 v66, v66, v74
  v_add_f32 v64, v64, v76
  v_add_f32 v66, v66, v78
  v_add_f32 v64, v64, v80
  v_add_f32 v66, v66, v82
  v_add_f32 v64, v64, v84
  v_add_f32 v66, v66, v86
  v_add_f32 v64, v64, v88
  v_add_f32 v66, v66, v90
  v_add_f32 v64, v64, v92
  v_add_f32 v66, v66, v94
  v_mul_f32 v144, 0x3abe82fa, v64
  v_mul_f32 v145, 0x3abe82fa, v66
  v_fma_f32 v145, -v144, v144, v145
  v_max_f32 v145, 0, v145
  v_add_f32 v145, 0x3727c5ac, v145
  v_rsq_f32 v146, v145
  s_nop 0
  v_mul_f32 v147, v144, v146
  v_lshlrev_b32 v4, 3, v24
  v_add_u32 v4, 122880, v4
  ds_write_b64 v4, v[146:147]
  s_waitcnt lgkmcnt(0)
k1p_51:
  s_barrier
  s_mul_i32 s48, s25, 6144
  v_lshlrev_b32 v6, 4, v1
  v_add_u32 v6, s48, v6
  v_add_u32 v7, 0, v6
  ds_read_b128 v[64:67], v7 offset:0
  ds_read_b128 v[68:71], v7 offset:1024
  ds_read_b128 v[72:75], v7 offset:2048
  ds_read_b128 v[76:79], v7 offset:3072
  ds_read_b128 v[80:83], v7 offset:4096
  ds_read_b128 v[84:87], v7 offset:5120
  s_mul_i32 s56, s29, 393216
  s_mul_i32 s49, s28, 24576
  s_add_u32 s56, s56, s49
  s_add_u32 s56, s56, 25165824
  s_waitcnt lgkmcnt(5)
  buffer_store_dwordx4 v[64:67], v6, s[20:23], s56 offen offset:0
  s_waitcnt lgkmcnt(4)
  buffer_store_dwordx4 v[68:71], v6, s[20:23], s56 offen offset:1024
  s_waitcnt lgkmcnt(3)
  buffer_store_dwordx4 v[72:75], v6, s[20:23], s56 offen offset:2048
  s_waitcnt lgkmcnt(2)
  buffer_store_dwordx4 v[76:79], v6, s[20:23], s56 offen offset:3072
  s_waitcnt lgkmcnt(1)
  s_add_u32 s48, s56, 4096
  buffer_store_dwordx4 v[80:83], v6, s[20:23], s48 offen offset:0
  s_waitcnt lgkmcnt(0)
  s_add_u32 s48, s56, 4096
  buffer_store_dwordx4 v[84:87], v6, s[20:23], s48 offen offset:1024
k1_end:
  s_endpgm
.globl k2_kernel
.p2align 8
.type k2_kernel,@function
k2_kernel:
  s_cmp_ge_u32 s2, 256
  s_cbranch_scc1 k2_end
  s_load_dwordx4 s[4:7], s[0:1], 40
  s_load_dwordx2 s[8:9], s[0:1], 88
  v_and_b32 v1, 63, v0
  v_lshrrev_b32 v2, 6, v0
  s_nop 0
  v_readfirstlane_b32 s24, v2
  s_and_b32 s46, s2, 7
  s_lshr_b32 s47, s2, 3
  s_lshr_b32 s28, s46, 1
  s_lshl_b32 s28, s28, 3
  s_lshr_b32 s48, s47, 2
  s_add_u32 s28, s28, s48
  s_and_b32 s29, s46, 1
  s_lshl_b32 s29, s29, 2
  s_and_b32 s48, s47, 3
  s_add_u32 s29, s29, s48
  s_mul_i32 s30, s29, 5
  s_min_u32 s48, s29, 3
  s_add_u32 s30, s30, s48
  s_waitcnt lgkmcnt(0)
  s_mov_b32 s12, s4
  s_and_b32 s13, s5, 0xffff
  s_mov_b32 s14, 8388608
  s_mov_b32 s15, 0x00020000
  s_mov_b32 s16, s6
  s_and_b32 s17, s7, 0xffff
  s_mov_b32 s18, 4096
  s_mov_b32 s19, 0x00020000
  s_mov_b32 s20, s8
  s_and_b32 s21, s9, 0xffff
  s_mov_b32 s22, 268435456
  s_mov_b32 s23, 0x00020000
  s_cmp_ge_u32 s24, 4
  s_cbranch_scc1 k2_prod
  s_and_b32 s25, s24, 1
  s_lshr_b32 s26, s24, 1
  v_and_b32 v13, 15, v1
  v_lshrrev_b32 v14, 4, v1
  v_and_b32 v15, 7, v13
  v_xor_b32 v15, v15, v14
  v_lshlrev_b32 v15, 4, v15
  v_lshl_add_u32 v15, v13, 7, v15
  s_lshl_b32 s48, s26, 12
  v_add_u32 v122, s48, v15
  v_xor_b32 v123, 64, v122
  v_bfe_u32 v15, v1, 2, 2
  v_lshl_add_u32 v15, v14, 3, v15
  v_mul_u32_u24 v15, 192, v15
  v_and_b32 v6, 1, v1
  v_lshl_add_u32 v15, v6, 3, v15
  v_bfe_u32 v6, v1, 1, 1
  v_and_b32 v7, 1, v14
  v_lshlrev_b32 v7, 1, v7
  s_mul_i32 s48, s25, 6
  s_add_u32 s49, s48, 0
  v_add_u32 v8, s49, v6
  v_xor_b32 v8, v8, v7
  v_lshl_add_u32 v8, v8, 4, v15
  v_add_u32 v2, 65536, v8
  v_add_u32 v9, 114688, v8
  s_add_u32 s49, s48, 2
  v_add_u32 v8, s49, v6
  v_xor_b32 v8, v8, v7
  v_lshl_add_u32 v8, v8, 4, v15
  v_add_u32 v3, 65536, v8
  v_add_u32 v10, 114688, v8
  s_add_u32 s49, s48, 4
  v_add_u32 v8, s49, v6
  v_xor_b32 v8, v8, v7
  v_lshl_add_u32 v8, v8, 4, v15
  v_add_u32 v4, 65536, v8
  v_add_u32 v11, 114688, v8
  v_mov_b32 v16, 0
  v_mov_b32 v17, 0
  v_mov_b32 v18, 0
  v_mov_b32 v19, 0
  v_mov_b32 v20, 0
  v_mov_b32 v21, 0
  v_mov_b32 v22, 0
  v_mov_b32 v23, 0
  v_mov_b32 v24, 0
  v_mov_b32 v25, 0
  v_mov_b32 v26, 0
  v_mov_b32 v27, 0
  v_mov_b32 v28, 0
  v_mov_b32 v29, 0
  v_mov_b32 v30, 0
  v_mov_b32 v31, 0
  v_mov_b32 v32, 0
  v_mov_b32 v33, 0
  v_mov_b32 v34, 0
  v_mov_b32 v35, 0
  v_mov_b32 v36, 0
  v_mov_b32 v37, 0
  v_mov_b32 v38, 0
  v_mov_b32 v39, 0
  s_lshl_b32 s48, s28, 6
  s_lshl_b32 s49, s26, 5
  s_add_u32 s48, s48, s49
  v_add_u32 v104, s48, v13
  v_lshlrev_b32 v105, 1, v104
  v_mul_u32_u24 v106, 192, v104
  v_lshl_add_u32 v106, v14, 3, v106
  s_mul_i32 s49, s25, 3
  s_add_u32 s49, s49, s30
  s_lshl_b32 s31, s49, 5
  s_mul_i32 s51, s29, 393216
  s_mul_i32 s49, s25, 96
  s_add_u32 s51, s51, s49
  s_add_u32 s51, s51, 25165824
  s_barrier
  ds_read_b64_tr_b16 v[40:41], v2 offset:0
  ds_read_b64_tr_b16 v[42:43], v2 offset:768
  ds_read_b64_tr_b16 v[44:45], v3 offset:0
  ds_read_b64_tr_b16 v[46:47], v3 offset:768
  ds_read_b64_tr_b16 v[48:49], v4 offset:0
  ds_read_b64_tr_b16 v[50:51], v4 offset:768
  ds_read_b128 v[52:55], v122 offset:0
  ds_read_b128 v[56:59], v122 offset:2048
  ds_read_b64_tr_b16 v[60:61], v2 offset:6144
  ds_read_b64_tr_b16 v[62:63], v2 offset:6912
  ds_read_b64_tr_b16 v[64:65], v3 offset:6144
  ds_read_b64_tr_b16 v[66:67], v3 offset:6912
  ds_read_b64_tr_b16 v[68:69], v4 offset:6144
  ds_read_b64_tr_b16 v[70:71], v4 offset:6912
  ds_read_b128 v[72:75], v123 offset:0
  ds_read_b128 v[76:79], v123 offset:2048
  s_barrier
  s_waitcnt lgkmcnt(8)
  v_mfma_f32_16x16x32_bf16 v[16:19], v[40:43], v[52:55], v[16:19]
  ds_read_b64_tr_b16 v[80:81], v2 offset:12288
  ds_read_b64_tr_b16 v[82:83], v2 offset:13056
  v_mfma_f32_16x16x32_bf16 v[20:23], v[40:43], v[56:59], v[20:23]
  ds_read_b64_tr_b16 v[84:85], v3 offset:12288
  ds_read_b64_tr_b16 v[86:87], v3 offset:13056
  v_mfma_f32_16x16x32_bf16 v[24:27], v[44:47], v[52:55], v[24:27]
  ds_read_b64_tr_b16 v[88:89], v4 offset:12288
  v_mfma_f32_16x16x32_bf16 v[28:31], v[44:47], v[56:59], v[28:31]
  ds_read_b64_tr_b16 v[90:91], v4 offset:13056
  v_mfma_f32_16x16x32_bf16 v[32:35], v[48:51], v[52:55], v[32:35]
  ds_read_b128 v[92:95], v122 offset:8192
  v_mfma_f32_16x16x32_bf16 v[36:39], v[48:51], v[56:59], v[36:39]
  ds_read_b128 v[96:99], v122 offset:10240
  s_waitcnt lgkmcnt(8)
  v_mfma_f32_16x16x32_bf16 v[16:19], v[60:63], v[72:75], v[16:19]
  ds_read_b64_tr_b16 v[40:41], v2 offset:18432
  ds_read_b64_tr_b16 v[42:43], v2 offset:19200
  v_mfma_f32_16x16x32_bf16 v[20:23], v[60:63], v[76:79], v[20:23]
  ds_read_b64_tr_b16 v[44:45], v3 offset:18432
  ds_read_b64_tr_b16 v[46:47], v3 offset:19200
  v_mfma_f32_16x16x32_bf16 v[24:27], v[64:67], v[72:75], v[24:27]
  ds_read_b64_tr_b16 v[48:49], v4 offset:18432
  v_mfma_f32_16x16x32_bf16 v[28:31], v[64:67], v[76:79], v[28:31]
  ds_read_b64_tr_b16 v[50:51], v4 offset:19200
  v_mfma_f32_16x16x32_bf16 v[32:35], v[68:71], v[72:75], v[32:35]
  ds_read_b128 v[52:55], v123 offset:8192
  v_mfma_f32_16x16x32_bf16 v[36:39], v[68:71], v[76:79], v[36:39]
  ds_read_b128 v[56:59], v123 offset:10240
  s_barrier
  s_waitcnt lgkmcnt(8)
  v_mfma_f32_16x16x32_bf16 v[16:19], v[80:83], v[92:95], v[16:19]
  ds_read_b64_tr_b16 v[60:61], v2 offset:24576
  ds_read_b64_tr_b16 v[62:63], v2 offset:25344
  v_mfma_f32_16x16x32_bf16 v[20:23], v[80:83], v[96:99], v[20:23]
  ds_read_b64_tr_b16 v[64:65], v3 offset:24576
  ds_read_b64_tr_b16 v[66:67], v3 offset:25344
  v_mfma_f32_16x16x32_bf16 v[24:27], v[84:87], v[92:95], v[24:27]
  ds_read_b64_tr_b16 v[68:69], v4 offset:24576
  v_mfma_f32_16x16x32_bf16 v[28:31], v[84:87], v[96:99], v[28:31]
  ds_read_b64_tr_b16 v[70:71], v4 offset:25344
  v_mfma_f32_16x16x32_bf16 v[32:35], v[88:91], v[92:95], v[32:35]
  ds_read_b128 v[72:75], v122 offset:16384
  v_mfma_f32_16x16x32_bf16 v[36:39], v[88:91], v[96:99], v[36:39]
  ds_read_b128 v[76:79], v122 offset:18432
  s_waitcnt lgkmcnt(8)
  v_mfma_f32_16x16x32_bf16 v[16:19], v[40:43], v[52:55], v[16:19]
  ds_read_b64_tr_b16 v[80:81], v2 offset:30720
  ds_read_b64_tr_b16 v[82:83], v2 offset:31488
  v_mfma_f32_16x16x32_bf16 v[20:23], v[40:43], v[56:59], v[20:23]
  ds_read_b64_tr_b16 v[84:85], v3 offset:30720
  ds_read_b64_tr_b16 v[86:87], v3 offset:31488
  v_mfma_f32_16x16x32_bf16 v[24:27], v[44:47], v[52:55], v[24:27]
  ds_read_b64_tr_b16 v[88:89], v4 offset:30720
  v_mfma_f32_16x16x32_bf16 v[28:31], v[44:47], v[56:59], v[28:31]
  ds_read_b64_tr_b16 v[90:91], v4 offset:31488
  v_mfma_f32_16x16x32_bf16 v[32:35], v[48:51], v[52:55], v[32:35]
  ds_read_b128 v[92:95], v123 offset:16384
  v_mfma_f32_16x16x32_bf16 v[36:39], v[48:51], v[56:59], v[36:39]
  ds_read_b128 v[96:99], v123 offset:18432
  s_barrier
  s_waitcnt lgkmcnt(8)
  v_mfma_f32_16x16x32_bf16 v[16:19], v[60:63], v[72:75], v[16:19]
  ds_read_b64_tr_b16 v[40:41], v2 offset:36864
  ds_read_b64_tr_b16 v[42:43], v2 offset:37632
  v_mfma_f32_16x16x32_bf16 v[20:23], v[60:63], v[76:79], v[20:23]
  ds_read_b64_tr_b16 v[44:45], v3 offset:36864
  ds_read_b64_tr_b16 v[46:47], v3 offset:37632
  v_mfma_f32_16x16x32_bf16 v[24:27], v[64:67], v[72:75], v[24:27]
  ds_read_b64_tr_b16 v[48:49], v4 offset:36864
  v_mfma_f32_16x16x32_bf16 v[28:31], v[64:67], v[76:79], v[28:31]
  ds_read_b64_tr_b16 v[50:51], v4 offset:37632
  v_mfma_f32_16x16x32_bf16 v[32:35], v[68:71], v[72:75], v[32:35]
  ds_read_b128 v[52:55], v122 offset:24576
  v_mfma_f32_16x16x32_bf16 v[36:39], v[68:71], v[76:79], v[36:39]
  ds_read_b128 v[56:59], v122 offset:26624
  s_waitcnt lgkmcnt(8)
  v_mfma_f32_16x16x32_bf16 v[16:19], v[80:83], v[92:95], v[16:19]
  ds_read_b64_tr_b16 v[60:61], v2 offset:43008
  ds_read_b64_tr_b16 v[62:63], v2 offset:43776
  v_mfma_f32_16x16x32_bf16 v[20:23], v[80:83], v[96:99], v[20:23]
  ds_read_b64_tr_b16 v[64:65], v3 offset:43008
  ds_read_b64_tr_b16 v[66:67], v3 offset:43776
  v_mfma_f32_16x16x32_bf16 v[24:27], v[84:87], v[92:95], v[24:27]
  ds_read_b64_tr_b16 v[68:69], v4 offset:43008
  v_mfma_f32_16x16x32_bf16 v[28:31], v[84:87], v[96:99], v[28:31]
  ds_read_b64_tr_b16 v[70:71], v4 offset:43776
  v_mfma_f32_16x16x32_bf16 v[32:35], v[88:91], v[92:95], v[32:35]
  ds_read_b128 v[72:75], v123 offset:24576
  v_mfma_f32_16x16x32_bf16 v[36:39], v[88:91], v[96:99], v[36:39]
  ds_read_b128 v[76:79], v123 offset:26624
  s_barrier
  s_waitcnt lgkmcnt(8)
  v_mfma_f32_16x16x32_bf16 v[16:19], v[40:43], v[52:55], v[16:19]
  ds_read_b64_tr_b16 v[80:81], v9 offset:0
  ds_read_b64_tr_b16 v[82:83], v9 offset:768
  v_mfma_f32_16x16x32_bf16 v[20:23], v[40:43], v[56:59], v[20:23]
  ds_read_b64_tr_b16 v[84:85], v10 offset:0
  ds_read_b64_tr_b16 v[86:87], v10 offset:768
  v_mfma_f32_16x16x32_bf16 v[24:27], v[44:47], v[52:55], v[24:27]
  ds_read_b64_tr_b16 v[88:89], v11 offset:0
  v_mfma_f32_16x16x32_bf16 v[28:31], v[44:47], v[56:59], v[28:31]
  ds_read_b64_tr_b16 v[90:91], v11 offset:768
  v_mfma_f32_16x16x32_bf16 v[32:35], v[48:51], v[52:55], v[32:35]
  ds_read_b128 v[92:95], v122 offset:32768
  v_mfma_f32_16x16x32_bf16 v[36:39], v[48:51], v[56:59], v[36:39]
  ds_read_b128 v[96:99], v122 offset:34816
  s_waitcnt lgkmcnt(8)
  v_mfma_f32_16x16x32_bf16 v[16:19], v[60:63], v[72:75], v[16:19]
  ds_read_b64_tr_b16 v[40:41], v9 offset:6144
  ds_read_b64_tr_b16 v[42:43], v9 offset:6912
  v_mfma_f32_16x16x32_bf16 v[20:23], v[60:63], v[76:79], v[20:23]
  ds_read_b64_tr_b16 v[44:45], v10 offset:6144
  ds_read_b64_tr_b16 v[46:47], v10 offset:6912
  v_mfma_f32_16x16x32_bf16 v[24:27], v[64:67], v[72:75], v[24:27]
  ds_read_b64_tr_b16 v[48:49], v11 offset:6144
  v_mfma_f32_16x16x32_bf16 v[28:31], v[64:67], v[76:79], v[28:31]
  ds_read_b64_tr_b16 v[50:51], v11 offset:6912
  v_mfma_f32_16x16x32_bf16 v[32:35], v[68:71], v[72:75], v[32:35]
  ds_read_b128 v[52:55], v123 offset:32768
  v_mfma_f32_16x16x32_bf16 v[36:39], v[68:71], v[76:79], v[36:39]
  ds_read_b128 v[56:59], v123 offset:34816
  s_barrier
  s_waitcnt lgkmcnt(8)
  v_mfma_f32_16x16x32_bf16 v[16:19], v[80:83], v[92:95], v[16:19]
  ds_read_b64_tr_b16 v[60:61], v9 offset:12288
  ds_read_b64_tr_b16 v[62:63], v9 offset:13056
  v_mfma_f32_16x16x32_bf16 v[20:23], v[80:83], v[96:99], v[20:23]
  ds_read_b64_tr_b16 v[64:65], v10 offset:12288
  ds_read_b64_tr_b16 v[66:67], v10 offset:13056
  v_mfma_f32_16x16x32_bf16 v[24:27], v[84:87], v[92:95], v[24:27]
  ds_read_b64_tr_b16 v[68:69], v11 offset:12288
  v_mfma_f32_16x16x32_bf16 v[28:31], v[84:87], v[96:99], v[28:31]
  ds_read_b64_tr_b16 v[70:71], v11 offset:13056
  v_mfma_f32_16x16x32_bf16 v[32:35], v[88:91], v[92:95], v[32:35]
  ds_read_b128 v[72:75], v122 offset:40960
  v_mfma_f32_16x16x32_bf16 v[36:39], v[88:91], v[96:99], v[36:39]
  ds_read_b128 v[76:79], v122 offset:43008
  s_waitcnt lgkmcnt(8)
  v_mfma_f32_16x16x32_bf16 v[16:19], v[40:43], v[52:55], v[16:19]
  ds_read_b64_tr_b16 v[80:81], v9 offset:18432
  ds_read_b64_tr_b16 v[82:83], v9 offset:19200
  v_mfma_f32_16x16x32_bf16 v[20:23], v[40:43], v[56:59], v[20:23]
  ds_read_b64_tr_b16 v[84:85], v10 offset:18432
  ds_read_b64_tr_b16 v[86:87], v10 offset:19200
  v_mfma_f32_16x16x32_bf16 v[24:27], v[44:47], v[52:55], v[24:27]
  ds_read_b64_tr_b16 v[88:89], v11 offset:18432
  v_mfma_f32_16x16x32_bf16 v[28:31], v[44:47], v[56:59], v[28:31]
  ds_read_b64_tr_b16 v[90:91], v11 offset:19200
  v_mfma_f32_16x16x32_bf16 v[32:35], v[48:51], v[52:55], v[32:35]
  ds_read_b128 v[92:95], v123 offset:40960
  v_mfma_f32_16x16x32_bf16 v[36:39], v[48:51], v[56:59], v[36:39]
  ds_read_b128 v[96:99], v123 offset:43008
  s_barrier
  s_waitcnt lgkmcnt(8)
  v_mfma_f32_16x16x32_bf16 v[16:19], v[60:63], v[72:75], v[16:19]
  ds_read_b64_tr_b16 v[40:41], v9 offset:24576
  ds_read_b64_tr_b16 v[42:43], v9 offset:25344
  v_mfma_f32_16x16x32_bf16 v[20:23], v[60:63], v[76:79], v[20:23]
  ds_read_b64_tr_b16 v[44:45], v10 offset:24576
  ds_read_b64_tr_b16 v[46:47], v10 offset:25344
  v_mfma_f32_16x16x32_bf16 v[24:27], v[64:67], v[72:75], v[24:27]
  ds_read_b64_tr_b16 v[48:49], v11 offset:24576
  v_mfma_f32_16x16x32_bf16 v[28:31], v[64:67], v[76:79], v[28:31]
  ds_read_b64_tr_b16 v[50:51], v11 offset:25344
  v_mfma_f32_16x16x32_bf16 v[32:35], v[68:71], v[72:75], v[32:35]
  ds_read_b128 v[52:55], v122 offset:49152
  v_mfma_f32_16x16x32_bf16 v[36:39], v[68:71], v[76:79], v[36:39]
  ds_read_b128 v[56:59], v122 offset:51200
  s_waitcnt lgkmcnt(8)
  v_mfma_f32_16x16x32_bf16 v[16:19], v[80:83], v[92:95], v[16:19]
  ds_read_b64_tr_b16 v[60:61], v9 offset:30720
  ds_read_b64_tr_b16 v[62:63], v9 offset:31488
  v_mfma_f32_16x16x32_bf16 v[20:23], v[80:83], v[96:99], v[20:23]
  ds_read_b64_tr_b16 v[64:65], v10 offset:30720
  ds_read_b64_tr_b16 v[66:67], v10 offset:31488
  v_mfma_f32_16x16x32_bf16 v[24:27], v[84:87], v[92:95], v[24:27]
  ds_read_b64_tr_b16 v[68:69], v11 offset:30720
  v_mfma_f32_16x16x32_bf16 v[28:31], v[84:87], v[96:99], v[28:31]
  ds_read_b64_tr_b16 v[70:71], v11 offset:31488
  v_mfma_f32_16x16x32_bf16 v[32:35], v[88:91], v[92:95], v[32:35]
  ds_read_b128 v[72:75], v123 offset:49152
  v_mfma_f32_16x16x32_bf16 v[36:39], v[88:91], v[96:99], v[36:39]
  ds_read_b128 v[76:79], v123 offset:51200
  s_barrier
  s_waitcnt lgkmcnt(8)
  v_mfma_f32_16x16x32_bf16 v[16:19], v[40:43], v[52:55], v[16:19]
  ds_read_b64_tr_b16 v[80:81], v9 offset:36864
  ds_read_b64_tr_b16 v[82:83], v9 offset:37632
  v_mfma_f32_16x16x32_bf16 v[20:23], v[40:43], v[56:59], v[20:23]
  ds_read_b64_tr_b16 v[84:85], v10 offset:36864
  ds_read_b64_tr_b16 v[86:87], v10 offset:37632
  v_mfma_f32_16x16x32_bf16 v[24:27], v[44:47], v[52:55], v[24:27]
  ds_read_b64_tr_b16 v[88:89], v11 offset:36864
  v_mfma_f32_16x16x32_bf16 v[28:31], v[44:47], v[56:59], v[28:31]
  ds_read_b64_tr_b16 v[90:91], v11 offset:37632
  v_mfma_f32_16x16x32_bf16 v[32:35], v[48:51], v[52:55], v[32:35]
  ds_read_b128 v[92:95], v122 offset:57344
  v_mfma_f32_16x16x32_bf16 v[36:39], v[48:51], v[56:59], v[36:39]
  ds_read_b128 v[96:99], v122 offset:59392
  s_waitcnt lgkmcnt(8)
  v_mfma_f32_16x16x32_bf16 v[16:19], v[60:63], v[72:75], v[16:19]
  ds_read_b64_tr_b16 v[40:41], v9 offset:43008
  ds_read_b64_tr_b16 v[42:43], v9 offset:43776
  v_mfma_f32_16x16x32_bf16 v[20:23], v[60:63], v[76:79], v[20:23]
  ds_read_b64_tr_b16 v[44:45], v10 offset:43008
  ds_read_b64_tr_b16 v[46:47], v10 offset:43776
  v_mfma_f32_16x16x32_bf16 v[24:27], v[64:67], v[72:75], v[24:27]
  ds_read_b64_tr_b16 v[48:49], v11 offset:43008
  v_mfma_f32_16x16x32_bf16 v[28:31], v[64:67], v[76:79], v[28:31]
  ds_read_b64_tr_b16 v[50:51], v11 offset:43776
  v_mfma_f32_16x16x32_bf16 v[32:35], v[68:71], v[72:75], v[32:35]
  ds_read_b128 v[52:55], v123 offset:57344
  v_mfma_f32_16x16x32_bf16 v[36:39], v[68:71], v[76:79], v[36:39]
  ds_read_b128 v[56:59], v123 offset:59392
  s_barrier
  s_waitcnt lgkmcnt(8)
  v_mfma_f32_16x16x32_bf16 v[16:19], v[80:83], v[92:95], v[16:19]
  ds_read_b64_tr_b16 v[60:61], v2 offset:0
  ds_read_b64_tr_b16 v[62:63], v2 offset:768
  v_mfma_f32_16x16x32_bf16 v[20:23], v[80:83], v[96:99], v[20:23]
  ds_read_b64_tr_b16 v[64:65], v3 offset:0
  ds_read_b64_tr_b16 v[66:67], v3 offset:768
  v_mfma_f32_16x16x32_bf16 v[24:27], v[84:87], v[92:95], v[24:27]
  ds_read_b64_tr_b16 v[68:69], v4 offset:0
  v_mfma_f32_16x16x32_bf16 v[28:31], v[84:87], v[96:99], v[28:31]
  ds_read_b64_tr_b16 v[70:71], v4 offset:768
  v_mfma_f32_16x16x32_bf16 v[32:35], v[88:91], v[92:95], v[32:35]
  ds_read_b128 v[72:75], v122 offset:0
  v_mfma_f32_16x16x32_bf16 v[36:39], v[88:91], v[96:99], v[36:39]
  ds_read_b128 v[76:79], v122 offset:2048
  s_waitcnt lgkmcnt(8)
  v_mfma_f32_16x16x32_bf16 v[16:19], v[40:43], v[52:55], v[16:19]
  ds_read_b64_tr_b16 v[80:81], v2 offset:6144
  ds_read_b64_tr_b16 v[82:83], v2 offset:6912
  v_mfma_f32_16x16x32_bf16 v[20:23], v[40:43], v[56:59], v[20:23]
  ds_read_b64_tr_b16 v[84:85], v3 offset:6144
  ds_read_b64_tr_b16 v[86:87], v3 offset:6912
  v_mfma_f32_16x16x32_bf16 v[24:27], v[44:47], v[52:55], v[24:27]
  ds_read_b64_tr_b16 v[88:89], v4 offset:6144
  v_mfma_f32_16x16x32_bf16 v[28:31], v[44:47], v[56:59], v[28:31]
  ds_read_b64_tr_b16 v[90:91], v4 offset:6912
  v_mfma_f32_16x16x32_bf16 v[32:35], v[48:51], v[52:55], v[32:35]
  ds_read_b128 v[92:95], v123 offset:0
  v_mfma_f32_16x16x32_bf16 v[36:39], v[48:51], v[56:59], v[36:39]
  ds_read_b128 v[96:99], v123 offset:2048
  buffer_load_ushort v120, v105, s[16:19], 0 offen
  buffer_load_ushort v121, v105, s[16:19], 0 offen offset:32
  s_add_u32 s49, s51, 0
  buffer_load_dwordx2 v[108:109], v106, s[20:23], s49 offen offset:0
  s_add_u32 s49, s51, 0
  buffer_load_dwordx2 v[110:111], v106, s[20:23], s49 offen offset:32
  s_add_u32 s49, s51, 0
  buffer_load_dwordx2 v[112:113], v106, s[20:23], s49 offen offset:64
  s_add_u32 s49, s51, 3072
  buffer_load_dwordx2 v[114:115], v106, s[20:23], s49 offen offset:0
  s_add_u32 s49, s51, 3072
  buffer_load_dwordx2 v[116:117], v106, s[20:23], s49 offen offset:32
  s_add_u32 s49, s51, 3072
  buffer_load_dwordx2 v[118:119], v106, s[20:23], s49 offen offset:64
  s_barrier
  s_waitcnt lgkmcnt(8)
  v_mfma_f32_16x16x32_bf16 v[16:19], v[60:63], v[72:75], v[16:19]
  ds_read_b64_tr_b16 v[40:41], v2 offset:12288
  ds_read_b64_tr_b16 v[42:43], v2 offset:13056
  v_mfma_f32_16x16x32_bf16 v[20:23], v[60:63], v[76:79], v[20:23]
  ds_read_b64_tr_b16 v[44:45], v3 offset:12288
  ds_read_b64_tr_b16 v[46:47], v3 offset:13056
  v_mfma_f32_16x16x32_bf16 v[24:27], v[64:67], v[72:75], v[24:27]
  ds_read_b64_tr_b16 v[48:49], v4 offset:12288
  v_mfma_f32_16x16x32_bf16 v[28:31], v[64:67], v[76:79], v[28:31]
  ds_read_b64_tr_b16 v[50:51], v4 offset:13056
  v_mfma_f32_16x16x32_bf16 v[32:35], v[68:71], v[72:75], v[32:35]
  ds_read_b128 v[52:55], v122 offset:8192
  v_mfma_f32_16x16x32_bf16 v[36:39], v[68:71], v[76:79], v[36:39]
  ds_read_b128 v[56:59], v122 offset:10240
  s_waitcnt lgkmcnt(8)
  v_mfma_f32_16x16x32_bf16 v[16:19], v[80:83], v[92:95], v[16:19]
  ds_read_b64_tr_b16 v[60:61], v2 offset:18432
  ds_read_b64_tr_b16 v[62:63], v2 offset:19200
  v_mfma_f32_16x16x32_bf16 v[20:23], v[80:83], v[96:99], v[20:23]
  ds_read_b64_tr_b16 v[64:65], v3 offset:18432
  ds_read_b64_tr_b16 v[66:67], v3 offset:19200
  v_mfma_f32_16x16x32_bf16 v[24:27], v[84:87], v[92:95], v[24:27]
  ds_read_b64_tr_b16 v[68:69], v4 offset:18432
  v_mfma_f32_16x16x32_bf16 v[28:31], v[84:87], v[96:99], v[28:31]
  ds_read_b64_tr_b16 v[70:71], v4 offset:19200
  v_mfma_f32_16x16x32_bf16 v[32:35], v[88:91], v[92:95], v[32:35]
  ds_read_b128 v[72:75], v123 offset:8192
  v_mfma_f32_16x16x32_bf16 v[36:39], v[88:91], v[96:99], v[36:39]
  ds_read_b128 v[76:79], v123 offset:10240
  s_barrier
  s_waitcnt lgkmcnt(8)
  v_mfma_f32_16x16x32_bf16 v[16:19], v[40:43], v[52:55], v[16:19]
  ds_read_b64_tr_b16 v[80:81], v2 offset:24576
  ds_read_b64_tr_b16 v[82:83], v2 offset:25344
  v_mfma_f32_16x16x32_bf16 v[20:23], v[40:43], v[56:59], v[20:23]
  ds_read_b64_tr_b16 v[84:85], v3 offset:24576
  ds_read_b64_tr_b16 v[86:87], v3 offset:25344
  v_mfma_f32_16x16x32_bf16 v[24:27], v[44:47], v[52:55], v[24:27]
  ds_read_b64_tr_b16 v[88:89], v4 offset:24576
  v_mfma_f32_16x16x32_bf16 v[28:31], v[44:47], v[56:59], v[28:31]
  ds_read_b64_tr_b16 v[90:91], v4 offset:25344
  v_mfma_f32_16x16x32_bf16 v[32:35], v[48:51], v[52:55], v[32:35]
  ds_read_b128 v[92:95], v122 offset:16384
  v_mfma_f32_16x16x32_bf16 v[36:39], v[48:51], v[56:59], v[36:39]
  ds_read_b128 v[96:99], v122 offset:18432
  s_waitcnt lgkmcnt(8)
  v_mfma_f32_16x16x32_bf16 v[16:19], v[60:63], v[72:75], v[16:19]
  ds_read_b64_tr_b16 v[40:41], v2 offset:30720
  ds_read_b64_tr_b16 v[42:43], v2 offset:31488
  v_mfma_f32_16x16x32_bf16 v[20:23], v[60:63], v[76:79], v[20:23]
  ds_read_b64_tr_b16 v[44:45], v3 offset:30720
  ds_read_b64_tr_b16 v[46:47], v3 offset:31488
  v_mfma_f32_16x16x32_bf16 v[24:27], v[64:67], v[72:75], v[24:27]
  ds_read_b64_tr_b16 v[48:49], v4 offset:30720
  v_mfma_f32_16x16x32_bf16 v[28:31], v[64:67], v[76:79], v[28:31]
  ds_read_b64_tr_b16 v[50:51], v4 offset:31488
  v_mfma_f32_16x16x32_bf16 v[32:35], v[68:71], v[72:75], v[32:35]
  ds_read_b128 v[52:55], v123 offset:16384
  v_mfma_f32_16x16x32_bf16 v[36:39], v[68:71], v[76:79], v[36:39]
  ds_read_b128 v[56:59], v123 offset:18432
  s_barrier
  s_waitcnt lgkmcnt(8)
  v_mfma_f32_16x16x32_bf16 v[16:19], v[80:83], v[92:95], v[16:19]
  ds_read_b64_tr_b16 v[60:61], v2 offset:36864
  ds_read_b64_tr_b16 v[62:63], v2 offset:37632
  v_mfma_f32_16x16x32_bf16 v[20:23], v[80:83], v[96:99], v[20:23]
  ds_read_b64_tr_b16 v[64:65], v3 offset:36864
  ds_read_b64_tr_b16 v[66:67], v3 offset:37632
  v_mfma_f32_16x16x32_bf16 v[24:27], v[84:87], v[92:95], v[24:27]
  ds_read_b64_tr_b16 v[68:69], v4 offset:36864
  v_mfma_f32_16x16x32_bf16 v[28:31], v[84:87], v[96:99], v[28:31]
  ds_read_b64_tr_b16 v[70:71], v4 offset:37632
  v_mfma_f32_16x16x32_bf16 v[32:35], v[88:91], v[92:95], v[32:35]
  ds_read_b128 v[72:75], v122 offset:24576
  v_mfma_f32_16x16x32_bf16 v[36:39], v[88:91], v[96:99], v[36:39]
  ds_read_b128 v[76:79], v122 offset:26624
  s_waitcnt lgkmcnt(8)
  v_mfma_f32_16x16x32_bf16 v[16:19], v[40:43], v[52:55], v[16:19]
  ds_read_b64_tr_b16 v[80:81], v2 offset:43008
  ds_read_b64_tr_b16 v[82:83], v2 offset:43776
  v_mfma_f32_16x16x32_bf16 v[20:23], v[40:43], v[56:59], v[20:23]
  ds_read_b64_tr_b16 v[84:85], v3 offset:43008
  ds_read_b64_tr_b16 v[86:87], v3 offset:43776
  v_mfma_f32_16x16x32_bf16 v[24:27], v[44:47], v[52:55], v[24:27]
  ds_read_b64_tr_b16 v[88:89], v4 offset:43008
  v_mfma_f32_16x16x32_bf16 v[28:31], v[44:47], v[56:59], v[28:31]
  ds_read_b64_tr_b16 v[90:91], v4 offset:43776
  v_mfma_f32_16x16x32_bf16 v[32:35], v[48:51], v[52:55], v[32:35]
  ds_read_b128 v[92:95], v123 offset:24576
  v_mfma_f32_16x16x32_bf16 v[36:39], v[48:51], v[56:59], v[36:39]
  ds_read_b128 v[96:99], v123 offset:26624
  s_barrier
  s_waitcnt lgkmcnt(8)
  v_mfma_f32_16x16x32_bf16 v[16:19], v[60:63], v[72:75], v[16:19]
  ds_read_b64_tr_b16 v[40:41], v9 offset:0
  ds_read_b64_tr_b16 v[42:43], v9 offset:768
  v_mfma_f32_16x16x32_bf16 v[20:23], v[60:63], v[76:79], v[20:23]
  ds_read_b64_tr_b16 v[44:45], v10 offset:0
  ds_read_b64_tr_b16 v[46:47], v10 offset:768
  v_mfma_f32_16x16x32_bf16 v[24:27], v[64:67], v[72:75], v[24:27]
  ds_read_b64_tr_b16 v[48:49], v11 offset:0
  v_mfma_f32_16x16x32_bf16 v[28:31], v[64:67], v[76:79], v[28:31]
  ds_read_b64_tr_b16 v[50:51], v11 offset:768
  v_mfma_f32_16x16x32_bf16 v[32:35], v[68:71], v[72:75], v[32:35]
  ds_read_b128 v[52:55], v122 offset:32768
  v_mfma_f32_16x16x32_bf16 v[36:39], v[68:71], v[76:79], v[36:39]
  ds_read_b128 v[56:59], v122 offset:34816
  s_waitcnt lgkmcnt(8)
  v_mfma_f32_16x16x32_bf16 v[16:19], v[80:83], v[92:95], v[16:19]
  ds_read_b64_tr_b16 v[60:61], v9 offset:6144
  ds_read_b64_tr_b16 v[62:63], v9 offset:6912
  v_mfma_f32_16x16x32_bf16 v[20:23], v[80:83], v[96:99], v[20:23]
  ds_read_b64_tr_b16 v[64:65], v10 offset:6144
  ds_read_b64_tr_b16 v[66:67], v10 offset:6912
  v_mfma_f32_16x16x32_bf16 v[24:27], v[84:87], v[92:95], v[24:27]
  ds_read_b64_tr_b16 v[68:69], v11 offset:6144
  v_mfma_f32_16x16x32_bf16 v[28:31], v[84:87], v[96:99], v[28:31]
  ds_read_b64_tr_b16 v[70:71], v11 offset:6912
  v_mfma_f32_16x16x32_bf16 v[32:35], v[88:91], v[92:95], v[32:35]
  ds_read_b128 v[72:75], v123 offset:32768
  v_mfma_f32_16x16x32_bf16 v[36:39], v[88:91], v[96:99], v[36:39]
  ds_read_b128 v[76:79], v123 offset:34816
  s_barrier
  s_waitcnt lgkmcnt(8)
  v_mfma_f32_16x16x32_bf16 v[16:19], v[40:43], v[52:55], v[16:19]
  ds_read_b64_tr_b16 v[80:81], v9 offset:12288
  ds_read_b64_tr_b16 v[82:83], v9 offset:13056
  v_mfma_f32_16x16x32_bf16 v[20:23], v[40:43], v[56:59], v[20:23]
  ds_read_b64_tr_b16 v[84:85], v10 offset:12288
  ds_read_b64_tr_b16 v[86:87], v10 offset:13056
  v_mfma_f32_16x16x32_bf16 v[24:27], v[44:47], v[52:55], v[24:27]
  ds_read_b64_tr_b16 v[88:89], v11 offset:12288
  v_mfma_f32_16x16x32_bf16 v[28:31], v[44:47], v[56:59], v[28:31]
  ds_read_b64_tr_b16 v[90:91], v11 offset:13056
  v_mfma_f32_16x16x32_bf16 v[32:35], v[48:51], v[52:55], v[32:35]
  ds_read_b128 v[92:95], v122 offset:40960
  v_mfma_f32_16x16x32_bf16 v[36:39], v[48:51], v[56:59], v[36:39]
  ds_read_b128 v[96:99], v122 offset:43008
  s_waitcnt lgkmcnt(8)
  v_mfma_f32_16x16x32_bf16 v[16:19], v[60:63], v[72:75], v[16:19]
  ds_read_b64_tr_b16 v[40:41], v9 offset:18432
  ds_read_b64_tr_b16 v[42:43], v9 offset:19200
  v_mfma_f32_16x16x32_bf16 v[20:23], v[60:63], v[76:79], v[20:23]
  ds_read_b64_tr_b16 v[44:45], v10 offset:18432
  ds_read_b64_tr_b16 v[46:47], v10 offset:19200
  v_mfma_f32_16x16x32_bf16 v[24:27], v[64:67], v[72:75], v[24:27]
  ds_read_b64_tr_b16 v[48:49], v11 offset:18432
  v_mfma_f32_16x16x32_bf16 v[28:31], v[64:67], v[76:79], v[28:31]
  ds_read_b64_tr_b16 v[50:51], v11 offset:19200
  v_mfma_f32_16x16x32_bf16 v[32:35], v[68:71], v[72:75], v[32:35]
  ds_read_b128 v[52:55], v123 offset:40960
  v_mfma_f32_16x16x32_bf16 v[36:39], v[68:71], v[76:79], v[36:39]
  ds_read_b128 v[56:59], v123 offset:43008
  s_barrier
  s_waitcnt lgkmcnt(8)
  v_mfma_f32_16x16x32_bf16 v[16:19], v[80:83], v[92:95], v[16:19]
  ds_read_b64_tr_b16 v[60:61], v9 offset:24576
  ds_read_b64_tr_b16 v[62:63], v9 offset:25344
  v_mfma_f32_16x16x32_bf16 v[20:23], v[80:83], v[96:99], v[20:23]
  ds_read_b64_tr_b16 v[64:65], v10 offset:24576
  ds_read_b64_tr_b16 v[66:67], v10 offset:25344
  v_mfma_f32_16x16x32_bf16 v[24:27], v[84:87], v[92:95], v[24:27]
  ds_read_b64_tr_b16 v[68:69], v11 offset:24576
  v_mfma_f32_16x16x32_bf16 v[28:31], v[84:87], v[96:99], v[28:31]
  ds_read_b64_tr_b16 v[70:71], v11 offset:25344
  v_mfma_f32_16x16x32_bf16 v[32:35], v[88:91], v[92:95], v[32:35]
  ds_read_b128 v[72:75], v122 offset:49152
  v_mfma_f32_16x16x32_bf16 v[36:39], v[88:91], v[96:99], v[36:39]
  ds_read_b128 v[76:79], v122 offset:51200
  s_waitcnt lgkmcnt(8)
  v_mfma_f32_16x16x32_bf16 v[16:19], v[40:43], v[52:55], v[16:19]
  ds_read_b64_tr_b16 v[80:81], v9 offset:30720
  ds_read_b64_tr_b16 v[82:83], v9 offset:31488
  v_mfma_f32_16x16x32_bf16 v[20:23], v[40:43], v[56:59], v[20:23]
  ds_read_b64_tr_b16 v[84:85], v10 offset:30720
  ds_read_b64_tr_b16 v[86:87], v10 offset:31488
  v_mfma_f32_16x16x32_bf16 v[24:27], v[44:47], v[52:55], v[24:27]
  ds_read_b64_tr_b16 v[88:89], v11 offset:30720
  v_mfma_f32_16x16x32_bf16 v[28:31], v[44:47], v[56:59], v[28:31]
  ds_read_b64_tr_b16 v[90:91], v11 offset:31488
  v_mfma_f32_16x16x32_bf16 v[32:35], v[48:51], v[52:55], v[32:35]
  ds_read_b128 v[92:95], v123 offset:49152
  v_mfma_f32_16x16x32_bf16 v[36:39], v[48:51], v[56:59], v[36:39]
  ds_read_b128 v[96:99], v123 offset:51200
  s_barrier
  s_waitcnt lgkmcnt(8)
  v_mfma_f32_16x16x32_bf16 v[16:19], v[60:63], v[72:75], v[16:19]
  ds_read_b64_tr_b16 v[40:41], v9 offset:36864
  ds_read_b64_tr_b16 v[42:43], v9 offset:37632
  v_mfma_f32_16x16x32_bf16 v[20:23], v[60:63], v[76:79], v[20:23]
  ds_read_b64_tr_b16 v[44:45], v10 offset:36864
  ds_read_b64_tr_b16 v[46:47], v10 offset:37632
  v_mfma_f32_16x16x32_bf16 v[24:27], v[64:67], v[72:75], v[24:27]
  ds_read_b64_tr_b16 v[48:49], v11 offset:36864
  v_mfma_f32_16x16x32_bf16 v[28:31], v[64:67], v[76:79], v[28:31]
  ds_read_b64_tr_b16 v[50:51], v11 offset:37632
  v_mfma_f32_16x16x32_bf16 v[32:35], v[68:71], v[72:75], v[32:35]
  ds_read_b128 v[52:55], v122 offset:57344
  v_mfma_f32_16x16x32_bf16 v[36:39], v[68:71], v[76:79], v[36:39]
  ds_read_b128 v[56:59], v122 offset:59392
  s_waitcnt lgkmcnt(8)
  v_mfma_f32_16x16x32_bf16 v[16:19], v[80:83], v[92:95], v[16:19]
  ds_read_b64_tr_b16 v[60:61], v9 offset:43008
  ds_read_b64_tr_b16 v[62:63], v9 offset:43776
  v_mfma_f32_16x16x32_bf16 v[20:23], v[80:83], v[96:99], v[20:23]
  ds_read_b64_tr_b16 v[64:65], v10 offset:43008
  ds_read_b64_tr_b16 v[66:67], v10 offset:43776
  v_mfma_f32_16x16x32_bf16 v[24:27], v[84:87], v[92:95], v[24:27]
  ds_read_b64_tr_b16 v[68:69], v11 offset:43008
  v_mfma_f32_16x16x32_bf16 v[28:31], v[84:87], v[96:99], v[28:31]
  ds_read_b64_tr_b16 v[70:71], v11 offset:43776
  v_mfma_f32_16x16x32_bf16 v[32:35], v[88:91], v[92:95], v[32:35]
  ds_read_b128 v[72:75], v123 offset:57344
  v_mfma_f32_16x16x32_bf16 v[36:39], v[88:91], v[96:99], v[36:39]
  ds_read_b128 v[76:79], v123 offset:59392
  s_barrier
  s_waitcnt lgkmcnt(8)
  v_mfma_f32_16x16x32_bf16 v[16:19], v[40:43], v[52:55], v[16:19]
  ds_read_b64_tr_b16 v[80:81], v2 offset:0
  ds_read_b64_tr_b16 v[82:83], v2 offset:768
  v_mfma_f32_16x16x32_bf16 v[20:23], v[40:43], v[56:59], v[20:23]
  ds_read_b64_tr_b16 v[84:85], v3 offset:0
  ds_read_b64_tr_b16 v[86:87], v3 offset:768
  v_mfma_f32_16x16x32_bf16 v[24:27], v[44:47], v[52:55], v[24:27]
  ds_read_b64_tr_b16 v[88:89], v4 offset:0
  v_mfma_f32_16x16x32_bf16 v[28:31], v[44:47], v[56:59], v[28:31]
  ds_read_b64_tr_b16 v[90:91], v4 offset:768
  v_mfma_f32_16x16x32_bf16 v[32:35], v[48:51], v[52:55], v[32:35]
  ds_read_b128 v[92:95], v122 offset:0
  v_mfma_f32_16x16x32_bf16 v[36:39], v[48:51], v[56:59], v[36:39]
  ds_read_b128 v[96:99], v122 offset:2048
  s_waitcnt lgkmcnt(8)
  v_mfma_f32_16x16x32_bf16 v[16:19], v[60:63], v[72:75], v[16:19]
  ds_read_b64_tr_b16 v[40:41], v2 offset:6144
  ds_read_b64_tr_b16 v[42:43], v2 offset:6912
  v_mfma_f32_16x16x32_bf16 v[20:23], v[60:63], v[76:79], v[20:23]
  ds_read_b64_tr_b16 v[44:45], v3 offset:6144
  ds_read_b64_tr_b16 v[46:47], v3 offset:6912
  v_mfma_f32_16x16x32_bf16 v[24:27], v[64:67], v[72:75], v[24:27]
  ds_read_b64_tr_b16 v[48:49], v4 offset:6144
  v_mfma_f32_16x16x32_bf16 v[28:31], v[64:67], v[76:79], v[28:31]
  ds_read_b64_tr_b16 v[50:51], v4 offset:6912
  v_mfma_f32_16x16x32_bf16 v[32:35], v[68:71], v[72:75], v[32:35]
  ds_read_b128 v[52:55], v123 offset:0
  v_mfma_f32_16x16x32_bf16 v[36:39], v[68:71], v[76:79], v[36:39]
  ds_read_b128 v[56:59], v123 offset:2048
  s_barrier
  s_waitcnt lgkmcnt(8)
  v_mfma_f32_16x16x32_bf16 v[16:19], v[80:83], v[92:95], v[16:19]
  ds_read_b64_tr_b16 v[60:61], v2 offset:12288
  ds_read_b64_tr_b16 v[62:63], v2 offset:13056
  v_mfma_f32_16x16x32_bf16 v[20:23], v[80:83], v[96:99], v[20:23]
  ds_read_b64_tr_b16 v[64:65], v3 offset:12288
  ds_read_b64_tr_b16 v[66:67], v3 offset:13056
  v_mfma_f32_16x16x32_bf16 v[24:27], v[84:87], v[92:95], v[24:27]
  ds_read_b64_tr_b16 v[68:69], v4 offset:12288
  v_mfma_f32_16x16x32_bf16 v[28:31], v[84:87], v[96:99], v[28:31]
  ds_read_b64_tr_b16 v[70:71], v4 offset:13056
  v_mfma_f32_16x16x32_bf16 v[32:35], v[88:91], v[92:95], v[32:35]
  ds_read_b128 v[72:75], v122 offset:8192
  v_mfma_f32_16x16x32_bf16 v[36:39], v[88:91], v[96:99], v[36:39]
  ds_read_b128 v[76:79], v122 offset:10240
  s_waitcnt lgkmcnt(8)
  v_mfma_f32_16x16x32_bf16 v[16:19], v[40:43], v[52:55], v[16:19]
  ds_read_b64_tr_b16 v[80:81], v2 offset:18432
  ds_read_b64_tr_b16 v[82:83], v2 offset:19200
  v_mfma_f32_16x16x32_bf16 v[20:23], v[40:43], v[56:59], v[20:23]
  ds_read_b64_tr_b16 v[84:85], v3 offset:18432
  ds_read_b64_tr_b16 v[86:87], v3 offset:19200
  v_mfma_f32_16x16x32_bf16 v[24:27], v[44:47], v[52:55], v[24:27]
  ds_read_b64_tr_b16 v[88:89], v4 offset:18432
  v_mfma_f32_16x16x32_bf16 v[28:31], v[44:47], v[56:59], v[28:31]
  ds_read_b64_tr_b16 v[90:91], v4 offset:19200
  v_mfma_f32_16x16x32_bf16 v[32:35], v[48:51], v[52:55], v[32:35]
  ds_read_b128 v[92:95], v123 offset:8192
  v_mfma_f32_16x16x32_bf16 v[36:39], v[48:51], v[56:59], v[36:39]
  ds_read_b128 v[96:99], v123 offset:10240
  s_barrier
  s_waitcnt lgkmcnt(8)
  v_mfma_f32_16x16x32_bf16 v[16:19], v[60:63], v[72:75], v[16:19]
  ds_read_b64_tr_b16 v[40:41], v2 offset:24576
  ds_read_b64_tr_b16 v[42:43], v2 offset:25344
  v_mfma_f32_16x16x32_bf16 v[20:23], v[60:63], v[76:79], v[20:23]
  ds_read_b64_tr_b16 v[44:45], v3 offset:24576
  ds_read_b64_tr_b16 v[46:47], v3 offset:25344
  v_mfma_f32_16x16x32_bf16 v[24:27], v[64:67], v[72:75], v[24:27]
  ds_read_b64_tr_b16 v[48:49], v4 offset:24576
  v_mfma_f32_16x16x32_bf16 v[28:31], v[64:67], v[76:79], v[28:31]
  ds_read_b64_tr_b16 v[50:51], v4 offset:25344
  v_mfma_f32_16x16x32_bf16 v[32:35], v[68:71], v[72:75], v[32:35]
  ds_read_b128 v[52:55], v122 offset:16384
  v_mfma_f32_16x16x32_bf16 v[36:39], v[68:71], v[76:79], v[36:39]
  ds_read_b128 v[56:59], v122 offset:18432
  s_waitcnt lgkmcnt(8)
  v_mfma_f32_16x16x32_bf16 v[16:19], v[80:83], v[92:95], v[16:19]
  ds_read_b64_tr_b16 v[60:61], v2 offset:30720
  ds_read_b64_tr_b16 v[62:63], v2 offset:31488
  v_mfma_f32_16x16x32_bf16 v[20:23], v[80:83], v[96:99], v[20:23]
  ds_read_b64_tr_b16 v[64:65], v3 offset:30720
  ds_read_b64_tr_b16 v[66:67], v3 offset:31488
  v_mfma_f32_16x16x32_bf16 v[24:27], v[84:87], v[92:95], v[24:27]
  ds_read_b64_tr_b16 v[68:69], v4 offset:30720
  v_mfma_f32_16x16x32_bf16 v[28:31], v[84:87], v[96:99], v[28:31]
  ds_read_b64_tr_b16 v[70:71], v4 offset:31488
  v_mfma_f32_16x16x32_bf16 v[32:35], v[88:91], v[92:95], v[32:35]
  ds_read_b128 v[72:75], v123 offset:16384
  v_mfma_f32_16x16x32_bf16 v[36:39], v[88:91], v[96:99], v[36:39]
  ds_read_b128 v[76:79], v123 offset:18432
  s_barrier
  s_waitcnt lgkmcnt(8)
  v_mfma_f32_16x16x32_bf16 v[16:19], v[40:43], v[52:55], v[16:19]
  ds_read_b64_tr_b16 v[80:81], v2 offset:36864
  ds_read_b64_tr_b16 v[82:83], v2 offset:37632
  v_mfma_f32_16x16x32_bf16 v[20:23], v[40:43], v[56:59], v[20:23]
  ds_read_b64_tr_b16 v[84:85], v3 offset:36864
  ds_read_b64_tr_b16 v[86:87], v3 offset:37632
  v_mfma_f32_16x16x32_bf16 v[24:27], v[44:47], v[52:55], v[24:27]
  ds_read_b64_tr_b16 v[88:89], v4 offset:36864
  v_mfma_f32_16x16x32_bf16 v[28:31], v[44:47], v[56:59], v[28:31]
  ds_read_b64_tr_b16 v[90:91], v4 offset:37632
  v_mfma_f32_16x16x32_bf16 v[32:35], v[48:51], v[52:55], v[32:35]
  ds_read_b128 v[92:95], v122 offset:24576
  v_mfma_f32_16x16x32_bf16 v[36:39], v[48:51], v[56:59], v[36:39]
  ds_read_b128 v[96:99], v122 offset:26624
  s_waitcnt lgkmcnt(8)
  v_mfma_f32_16x16x32_bf16 v[16:19], v[60:63], v[72:75], v[16:19]
  ds_read_b64_tr_b16 v[40:41], v2 offset:43008
  ds_read_b64_tr_b16 v[42:43], v2 offset:43776
  v_mfma_f32_16x16x32_bf16 v[20:23], v[60:63], v[76:79], v[20:23]
  ds_read_b64_tr_b16 v[44:45], v3 offset:43008
  ds_read_b64_tr_b16 v[46:47], v3 offset:43776
  v_mfma_f32_16x16x32_bf16 v[24:27], v[64:67], v[72:75], v[24:27]
  ds_read_b64_tr_b16 v[48:49], v4 offset:43008
  v_mfma_f32_16x16x32_bf16 v[28:31], v[64:67], v[76:79], v[28:31]
  ds_read_b64_tr_b16 v[50:51], v4 offset:43776
  v_mfma_f32_16x16x32_bf16 v[32:35], v[68:71], v[72:75], v[32:35]
  ds_read_b128 v[52:55], v123 offset:24576
  v_mfma_f32_16x16x32_bf16 v[36:39], v[68:71], v[76:79], v[36:39]
  ds_read_b128 v[56:59], v123 offset:26624
  s_barrier
  s_waitcnt lgkmcnt(8)
  v_mfma_f32_16x16x32_bf16 v[16:19], v[80:83], v[92:95], v[16:19]
  ds_read_b64_tr_b16 v[60:61], v9 offset:0
  ds_read_b64_tr_b16 v[62:63], v9 offset:768
  v_mfma_f32_16x16x32_bf16 v[20:23], v[80:83], v[96:99], v[20:23]
  ds_read_b64_tr_b16 v[64:65], v10 offset:0
  ds_read_b64_tr_b16 v[66:67], v10 offset:768
  v_mfma_f32_16x16x32_bf16 v[24:27], v[84:87], v[92:95], v[24:27]
  ds_read_b64_tr_b16 v[68:69], v11 offset:0
  v_mfma_f32_16x16x32_bf16 v[28:31], v[84:87], v[96:99], v[28:31]
  ds_read_b64_tr_b16 v[70:71], v11 offset:768
  v_mfma_f32_16x16x32_bf16 v[32:35], v[88:91], v[92:95], v[32:35]
  ds_read_b128 v[72:75], v122 offset:32768
  v_mfma_f32_16x16x32_bf16 v[36:39], v[88:91], v[96:99], v[36:39]
  ds_read_b128 v[76:79], v122 offset:34816
  s_waitcnt lgkmcnt(8)
  v_mfma_f32_16x16x32_bf16 v[16:19], v[40:43], v[52:55], v[16:19]
  ds_read_b64_tr_b16 v[80:81], v9 offset:6144
  ds_read_b64_tr_b16 v[82:83], v9 offset:6912
  v_mfma_f32_16x16x32_bf16 v[20:23], v[40:43], v[56:59], v[20:23]
  ds_read_b64_tr_b16 v[84:85], v10 offset:6144
  ds_read_b64_tr_b16 v[86:87], v10 offset:6912
  v_mfma_f32_16x16x32_bf16 v[24:27], v[44:47], v[52:55], v[24:27]
  ds_read_b64_tr_b16 v[88:89], v11 offset:6144
  v_mfma_f32_16x16x32_bf16 v[28:31], v[44:47], v[56:59], v[28:31]
  ds_read_b64_tr_b16 v[90:91], v11 offset:6912
  v_mfma_f32_16x16x32_bf16 v[32:35], v[48:51], v[52:55], v[32:35]
  ds_read_b128 v[92:95], v123 offset:32768
  v_mfma_f32_16x16x32_bf16 v[36:39], v[48:51], v[56:59], v[36:39]
  ds_read_b128 v[96:99], v123 offset:34816
  s_barrier
  s_waitcnt lgkmcnt(8)
  v_mfma_f32_16x16x32_bf16 v[16:19], v[60:63], v[72:75], v[16:19]
  ds_read_b64_tr_b16 v[40:41], v9 offset:12288
  ds_read_b64_tr_b16 v[42:43], v9 offset:13056
  v_mfma_f32_16x16x32_bf16 v[20:23], v[60:63], v[76:79], v[20:23]
  ds_read_b64_tr_b16 v[44:45], v10 offset:12288
  ds_read_b64_tr_b16 v[46:47], v10 offset:13056
  v_mfma_f32_16x16x32_bf16 v[24:27], v[64:67], v[72:75], v[24:27]
  ds_read_b64_tr_b16 v[48:49], v11 offset:12288
  v_mfma_f32_16x16x32_bf16 v[28:31], v[64:67], v[76:79], v[28:31]
  ds_read_b64_tr_b16 v[50:51], v11 offset:13056
  v_mfma_f32_16x16x32_bf16 v[32:35], v[68:71], v[72:75], v[32:35]
  ds_read_b128 v[52:55], v122 offset:40960
  v_mfma_f32_16x16x32_bf16 v[36:39], v[68:71], v[76:79], v[36:39]
  ds_read_b128 v[56:59], v122 offset:43008
  s_waitcnt lgkmcnt(8)
  v_mfma_f32_16x16x32_bf16 v[16:19], v[80:83], v[92:95], v[16:19]
  ds_read_b64_tr_b16 v[60:61], v9 offset:18432
  ds_read_b64_tr_b16 v[62:63], v9 offset:19200
  v_mfma_f32_16x16x32_bf16 v[20:23], v[80:83], v[96:99], v[20:23]
  ds_read_b64_tr_b16 v[64:65], v10 offset:18432
  ds_read_b64_tr_b16 v[66:67], v10 offset:19200
  v_mfma_f32_16x16x32_bf16 v[24:27], v[84:87], v[92:95], v[24:27]
  ds_read_b64_tr_b16 v[68:69], v11 offset:18432
  v_mfma_f32_16x16x32_bf16 v[28:31], v[84:87], v[96:99], v[28:31]
  ds_read_b64_tr_b16 v[70:71], v11 offset:19200
  v_mfma_f32_16x16x32_bf16 v[32:35], v[88:91], v[92:95], v[32:35]
  ds_read_b128 v[72:75], v123 offset:40960
  v_mfma_f32_16x16x32_bf16 v[36:39], v[88:91], v[96:99], v[36:39]
  ds_read_b128 v[76:79], v123 offset:43008
  s_barrier
  s_waitcnt lgkmcnt(8)
  v_mfma_f32_16x16x32_bf16 v[16:19], v[40:43], v[52:55], v[16:19]
  ds_read_b64_tr_b16 v[80:81], v9 offset:24576
  ds_read_b64_tr_b16 v[82:83], v9 offset:25344
  v_mfma_f32_16x16x32_bf16 v[20:23], v[40:43], v[56:59], v[20:23]
  ds_read_b64_tr_b16 v[84:85], v10 offset:24576
  ds_read_b64_tr_b16 v[86:87], v10 offset:25344
  v_mfma_f32_16x16x32_bf16 v[24:27], v[44:47], v[52:55], v[24:27]
  ds_read_b64_tr_b16 v[88:89], v11 offset:24576
  v_mfma_f32_16x16x32_bf16 v[28:31], v[44:47], v[56:59], v[28:31]
  ds_read_b64_tr_b16 v[90:91], v11 offset:25344
  v_mfma_f32_16x16x32_bf16 v[32:35], v[48:51], v[52:55], v[32:35]
  ds_read_b128 v[92:95], v122 offset:49152
  v_mfma_f32_16x16x32_bf16 v[36:39], v[48:51], v[56:59], v[36:39]
  ds_read_b128 v[96:99], v122 offset:51200
  s_waitcnt lgkmcnt(8)
  v_mfma_f32_16x16x32_bf16 v[16:19], v[60:63], v[72:75], v[16:19]
  ds_read_b64_tr_b16 v[40:41], v9 offset:30720
  ds_read_b64_tr_b16 v[42:43], v9 offset:31488
  v_mfma_f32_16x16x32_bf16 v[20:23], v[60:63], v[76:79], v[20:23]
  ds_read_b64_tr_b16 v[44:45], v10 offset:30720
  ds_read_b64_tr_b16 v[46:47], v10 offset:31488
  v_mfma_f32_16x16x32_bf16 v[24:27], v[64:67], v[72:75], v[24:27]
  ds_read_b64_tr_b16 v[48:49], v11 offset:30720
  v_mfma_f32_16x16x32_bf16 v[28:31], v[64:67], v[76:79], v[28:31]
  ds_read_b64_tr_b16 v[50:51], v11 offset:31488
  v_mfma_f32_16x16x32_bf16 v[32:35], v[68:71], v[72:75], v[32:35]
  ds_read_b128 v[52:55], v123 offset:49152
  v_mfma_f32_16x16x32_bf16 v[36:39], v[68:71], v[76:79], v[36:39]
  ds_read_b128 v[56:59], v123 offset:51200
  s_barrier
  s_waitcnt lgkmcnt(8)
  v_mfma_f32_16x16x32_bf16 v[16:19], v[80:83], v[92:95], v[16:19]
  ds_read_b64_tr_b16 v[60:61], v9 offset:36864
  ds_read_b64_tr_b16 v[62:63], v9 offset:37632
  v_mfma_f32_16x16x32_bf16 v[20:23], v[80:83], v[96:99], v[20:23]
  ds_read_b64_tr_b16 v[64:65], v10 offset:36864
  ds_read_b64_tr_b16 v[66:67], v10 offset:37632
  v_mfma_f32_16x16x32_bf16 v[24:27], v[84:87], v[92:95], v[24:27]
  ds_read_b64_tr_b16 v[68:69], v11 offset:36864
  v_mfma_f32_16x16x32_bf16 v[28:31], v[84:87], v[96:99], v[28:31]
  ds_read_b64_tr_b16 v[70:71], v11 offset:37632
  v_mfma_f32_16x16x32_bf16 v[32:35], v[88:91], v[92:95], v[32:35]
  ds_read_b128 v[72:75], v122 offset:57344
  v_mfma_f32_16x16x32_bf16 v[36:39], v[88:91], v[96:99], v[36:39]
  ds_read_b128 v[76:79], v122 offset:59392
  s_waitcnt lgkmcnt(8)
  v_mfma_f32_16x16x32_bf16 v[16:19], v[40:43], v[52:55], v[16:19]
  ds_read_b64_tr_b16 v[80:81], v9 offset:43008
  ds_read_b64_tr_b16 v[82:83], v9 offset:43776
  v_mfma_f32_16x16x32_bf16 v[20:23], v[40:43], v[56:59], v[20:23]
  ds_read_b64_tr_b16 v[84:85], v10 offset:43008
  ds_read_b64_tr_b16 v[86:87], v10 offset:43776
  v_mfma_f32_16x16x32_bf16 v[24:27], v[44:47], v[52:55], v[24:27]
  ds_read_b64_tr_b16 v[88:89], v11 offset:43008
  v_mfma_f32_16x16x32_bf16 v[28:31], v[44:47], v[56:59], v[28:31]
  ds_read_b64_tr_b16 v[90:91], v11 offset:43776
  v_mfma_f32_16x16x32_bf16 v[32:35], v[48:51], v[52:55], v[32:35]
  ds_read_b128 v[92:95], v123 offset:57344
  v_mfma_f32_16x16x32_bf16 v[36:39], v[48:51], v[56:59], v[36:39]
  ds_read_b128 v[96:99], v123 offset:59392
  s_barrier
  s_waitcnt lgkmcnt(8)
  v_mfma_f32_16x16x32_bf16 v[16:19], v[60:63], v[72:75], v[16:19]
  ds_read_b64_tr_b16 v[40:41], v2 offset:0
  ds_read_b64_tr_b16 v[42:43], v2 offset:768
  v_mfma_f32_16x16x32_bf16 v[20:23], v[60:63], v[76:79], v[20:23]
  ds_read_b64_tr_b16 v[44:45], v3 offset:0
  ds_read_b64_tr_b16 v[46:47], v3 offset:768
  v_mfma_f32_16x16x32_bf16 v[24:27], v[64:67], v[72:75], v[24:27]
  ds_read_b64_tr_b16 v[48:49], v4 offset:0
  v_mfma_f32_16x16x32_bf16 v[28:31], v[64:67], v[76:79], v[28:31]
  ds_read_b64_tr_b16 v[50:51], v4 offset:768
  v_mfma_f32_16x16x32_bf16 v[32:35], v[68:71], v[72:75], v[32:35]
  ds_read_b128 v[52:55], v122 offset:0
  v_mfma_f32_16x16x32_bf16 v[36:39], v[68:71], v[76:79], v[36:39]
  ds_read_b128 v[56:59], v122 offset:2048
  s_waitcnt lgkmcnt(8)
  v_mfma_f32_16x16x32_bf16 v[16:19], v[80:83], v[92:95], v[16:19]
  ds_read_b64_tr_b16 v[60:61], v2 offset:6144
  ds_read_b64_tr_b16 v[62:63], v2 offset:6912
  v_mfma_f32_16x16x32_bf16 v[20:23], v[80:83], v[96:99], v[20:23]
  ds_read_b64_tr_b16 v[64:65], v3 offset:6144
  ds_read_b64_tr_b16 v[66:67], v3 offset:6912
  v_mfma_f32_16x16x32_bf16 v[24:27], v[84:87], v[92:95], v[24:27]
  ds_read_b64_tr_b16 v[68:69], v4 offset:6144
  v_mfma_f32_16x16x32_bf16 v[28:31], v[84:87], v[96:99], v[28:31]
  ds_read_b64_tr_b16 v[70:71], v4 offset:6912
  v_mfma_f32_16x16x32_bf16 v[32:35], v[88:91], v[92:95], v[32:35]
  ds_read_b128 v[72:75], v123 offset:0
  v_mfma_f32_16x16x32_bf16 v[36:39], v[88:91], v[96:99], v[36:39]
  ds_read_b128 v[76:79], v123 offset:2048
  s_barrier
  s_waitcnt lgkmcnt(8)
  v_mfma_f32_16x16x32_bf16 v[16:19], v[40:43], v[52:55], v[16:19]
  ds_read_b64_tr_b16 v[80:81], v2 offset:12288
  ds_read_b64_tr_b16 v[82:83], v2 offset:13056
  v_mfma_f32_16x16x32_bf16 v[20:23], v[40:43], v[56:59], v[20:23]
  ds_read_b64_tr_b16 v[84:85], v3 offset:12288
  ds_read_b64_tr_b16 v[86:87], v3 offset:13056
  v_mfma_f32_16x16x32_bf16 v[24:27], v[44:47], v[52:55], v[24:27]
  ds_read_b64_tr_b16 v[88:89], v4 offset:12288
  v_mfma_f32_16x16x32_bf16 v[28:31], v[44:47], v[56:59], v[28:31]
  ds_read_b64_tr_b16 v[90:91], v4 offset:13056
  v_mfma_f32_16x16x32_bf16 v[32:35], v[48:51], v[52:55], v[32:35]
  ds_read_b128 v[92:95], v122 offset:8192
  v_mfma_f32_16x16x32_bf16 v[36:39], v[48:51], v[56:59], v[36:39]
  ds_read_b128 v[96:99], v122 offset:10240
  s_waitcnt lgkmcnt(8)
  v_mfma_f32_16x16x32_bf16 v[16:19], v[60:63], v[72:75], v[16:19]
  ds_read_b64_tr_b16 v[40:41], v2 offset:18432
  ds_read_b64_tr_b16 v[42:43], v2 offset:19200
  v_mfma_f32_16x16x32_bf16 v[20:23], v[60:63], v[76:79], v[20:23]
  ds_read_b64_tr_b16 v[44:45], v3 offset:18432
  ds_read_b64_tr_b16 v[46:47], v3 offset:19200
  v_mfma_f32_16x16x32_bf16 v[24:27], v[64:67], v[72:75], v[24:27]
  ds_read_b64_tr_b16 v[48:49], v4 offset:18432
  v_mfma_f32_16x16x32_bf16 v[28:31], v[64:67], v[76:79], v[28:31]
  ds_read_b64_tr_b16 v[50:51], v4 offset:19200
  v_mfma_f32_16x16x32_bf16 v[32:35], v[68:71], v[72:75], v[32:35]
  ds_read_b128 v[52:55], v123 offset:8192
  v_mfma_f32_16x16x32_bf16 v[36:39], v[68:71], v[76:79], v[36:39]
  ds_read_b128 v[56:59], v123 offset:10240
  s_barrier
  s_waitcnt lgkmcnt(8)
  v_mfma_f32_16x16x32_bf16 v[16:19], v[80:83], v[92:95], v[16:19]
  ds_read_b64_tr_b16 v[60:61], v2 offset:24576
  ds_read_b64_tr_b16 v[62:63], v2 offset:25344
  v_mfma_f32_16x16x32_bf16 v[20:23], v[80:83], v[96:99], v[20:23]
  ds_read_b64_tr_b16 v[64:65], v3 offset:24576
  ds_read_b64_tr_b16 v[66:67], v3 offset:25344
  v_mfma_f32_16x16x32_bf16 v[24:27], v[84:87], v[92:95], v[24:27]
  ds_read_b64_tr_b16 v[68:69], v4 offset:24576
  v_mfma_f32_16x16x32_bf16 v[28:31], v[84:87], v[96:99], v[28:31]
  ds_read_b64_tr_b16 v[70:71], v4 offset:25344
  v_mfma_f32_16x16x32_bf16 v[32:35], v[88:91], v[92:95], v[32:35]
  ds_read_b128 v[72:75], v122 offset:16384
  v_mfma_f32_16x16x32_bf16 v[36:39], v[88:91], v[96:99], v[36:39]
  ds_read_b128 v[76:79], v122 offset:18432
  s_waitcnt lgkmcnt(8)
  v_mfma_f32_16x16x32_bf16 v[16:19], v[40:43], v[52:55], v[16:19]
  ds_read_b64_tr_b16 v[80:81], v2 offset:30720
  ds_read_b64_tr_b16 v[82:83], v2 offset:31488
  v_mfma_f32_16x16x32_bf16 v[20:23], v[40:43], v[56:59], v[20:23]
  ds_read_b64_tr_b16 v[84:85], v3 offset:30720
  ds_read_b64_tr_b16 v[86:87], v3 offset:31488
  v_mfma_f32_16x16x32_bf16 v[24:27], v[44:47], v[52:55], v[24:27]
  ds_read_b64_tr_b16 v[88:89], v4 offset:30720
  v_mfma_f32_16x16x32_bf16 v[28:31], v[44:47], v[56:59], v[28:31]
  ds_read_b64_tr_b16 v[90:91], v4 offset:31488
  v_mfma_f32_16x16x32_bf16 v[32:35], v[48:51], v[52:55], v[32:35]
  ds_read_b128 v[92:95], v123 offset:16384
  v_mfma_f32_16x16x32_bf16 v[36:39], v[48:51], v[56:59], v[36:39]
  ds_read_b128 v[96:99], v123 offset:18432
  s_barrier
  s_waitcnt lgkmcnt(8)
  v_mfma_f32_16x16x32_bf16 v[16:19], v[60:63], v[72:75], v[16:19]
  ds_read_b64_tr_b16 v[40:41], v2 offset:36864
  ds_read_b64_tr_b16 v[42:43], v2 offset:37632
  v_mfma_f32_16x16x32_bf16 v[20:23], v[60:63], v[76:79], v[20:23]
  ds_read_b64_tr_b16 v[44:45], v3 offset:36864
  ds_read_b64_tr_b16 v[46:47], v3 offset:37632
  v_mfma_f32_16x16x32_bf16 v[24:27], v[64:67], v[72:75], v[24:27]
  ds_read_b64_tr_b16 v[48:49], v4 offset:36864
  v_mfma_f32_16x16x32_bf16 v[28:31], v[64:67], v[76:79], v[28:31]
  ds_read_b64_tr_b16 v[50:51], v4 offset:37632
  v_mfma_f32_16x16x32_bf16 v[32:35], v[68:71], v[72:75], v[32:35]
  ds_read_b128 v[52:55], v122 offset:24576
  v_mfma_f32_16x16x32_bf16 v[36:39], v[68:71], v[76:79], v[36:39]
  ds_read_b128 v[56:59], v122 offset:26624
  s_waitcnt lgkmcnt(8)
  v_mfma_f32_16x16x32_bf16 v[16:19], v[80:83], v[92:95], v[16:19]
  ds_read_b64_tr_b16 v[60:61], v2 offset:43008
  ds_read_b64_tr_b16 v[62:63], v2 offset:43776
  v_mfma_f32_16x16x32_bf16 v[20:23], v[80:83], v[96:99], v[20:23]
  ds_read_b64_tr_b16 v[64:65], v3 offset:43008
  ds_read_b64_tr_b16 v[66:67], v3 offset:43776
  v_mfma_f32_16x16x32_bf16 v[24:27], v[84:87], v[92:95], v[24:27]
  ds_read_b64_tr_b16 v[68:69], v4 offset:43008
  v_mfma_f32_16x16x32_bf16 v[28:31], v[84:87], v[96:99], v[28:31]
  ds_read_b64_tr_b16 v[70:71], v4 offset:43776
  v_mfma_f32_16x16x32_bf16 v[32:35], v[88:91], v[92:95], v[32:35]
  ds_read_b128 v[72:75], v123 offset:24576
  v_mfma_f32_16x16x32_bf16 v[36:39], v[88:91], v[96:99], v[36:39]
  ds_read_b128 v[76:79], v123 offset:26624
  s_barrier
  s_waitcnt lgkmcnt(8)
  v_mfma_f32_16x16x32_bf16 v[16:19], v[40:43], v[52:55], v[16:19]
  ds_read_b64_tr_b16 v[80:81], v9 offset:0
  ds_read_b64_tr_b16 v[82:83], v9 offset:768
  v_mfma_f32_16x16x32_bf16 v[20:23], v[40:43], v[56:59], v[20:23]
  ds_read_b64_tr_b16 v[84:85], v10 offset:0
  ds_read_b64_tr_b16 v[86:87], v10 offset:768
  v_mfma_f32_16x16x32_bf16 v[24:27], v[44:47], v[52:55], v[24:27]
  ds_read_b64_tr_b16 v[88:89], v11 offset:0
  v_mfma_f32_16x16x32_bf16 v[28:31], v[44:47], v[56:59], v[28:31]
  ds_read_b64_tr_b16 v[90:91], v11 offset:768
  v_mfma_f32_16x16x32_bf16 v[32:35], v[48:51], v[52:55], v[32:35]
  ds_read_b128 v[92:95], v122 offset:32768
  v_mfma_f32_16x16x32_bf16 v[36:39], v[48:51], v[56:59], v[36:39]
  ds_read_b128 v[96:99], v122 offset:34816
  s_waitcnt lgkmcnt(8)
  v_mfma_f32_16x16x32_bf16 v[16:19], v[60:63], v[72:75], v[16:19]
  ds_read_b64_tr_b16 v[40:41], v9 offset:6144
  ds_read_b64_tr_b16 v[42:43], v9 offset:6912
  v_mfma_f32_16x16x32_bf16 v[20:23], v[60:63], v[76:79], v[20:23]
  ds_read_b64_tr_b16 v[44:45], v10 offset:6144
  ds_read_b64_tr_b16 v[46:47], v10 offset:6912
  v_mfma_f32_16x16x32_bf16 v[24:27], v[64:67], v[72:75], v[24:27]
  ds_read_b64_tr_b16 v[48:49], v11 offset:6144
  v_mfma_f32_16x16x32_bf16 v[28:31], v[64:67], v[76:79], v[28:31]
  ds_read_b64_tr_b16 v[50:51], v11 offset:6912
  v_mfma_f32_16x16x32_bf16 v[32:35], v[68:71], v[72:75], v[32:35]
  ds_read_b128 v[52:55], v123 offset:32768
  v_mfma_f32_16x16x32_bf16 v[36:39], v[68:71], v[76:79], v[36:39]
  ds_read_b128 v[56:59], v123 offset:34816
  s_barrier
  s_waitcnt lgkmcnt(8)
  v_mfma_f32_16x16x32_bf16 v[16:19], v[80:83], v[92:95], v[16:19]
  ds_read_b64_tr_b16 v[60:61], v9 offset:12288
  ds_read_b64_tr_b16 v[62:63], v9 offset:13056
  v_mfma_f32_16x16x32_bf16 v[20:23], v[80:83], v[96:99], v[20:23]
  ds_read_b64_tr_b16 v[64:65], v10 offset:12288
  ds_read_b64_tr_b16 v[66:67], v10 offset:13056
  v_mfma_f32_16x16x32_bf16 v[24:27], v[84:87], v[92:95], v[24:27]
  ds_read_b64_tr_b16 v[68:69], v11 offset:12288
  v_mfma_f32_16x16x32_bf16 v[28:31], v[84:87], v[96:99], v[28:31]
  ds_read_b64_tr_b16 v[70:71], v11 offset:13056
  v_mfma_f32_16x16x32_bf16 v[32:35], v[88:91], v[92:95], v[32:35]
  ds_read_b128 v[72:75], v122 offset:40960
  v_mfma_f32_16x16x32_bf16 v[36:39], v[88:91], v[96:99], v[36:39]
  ds_read_b128 v[76:79], v122 offset:43008
  s_waitcnt lgkmcnt(8)
  v_mfma_f32_16x16x32_bf16 v[16:19], v[40:43], v[52:55], v[16:19]
  ds_read_b64_tr_b16 v[80:81], v9 offset:18432
  ds_read_b64_tr_b16 v[82:83], v9 offset:19200
  v_mfma_f32_16x16x32_bf16 v[20:23], v[40:43], v[56:59], v[20:23]
  ds_read_b64_tr_b16 v[84:85], v10 offset:18432
  ds_read_b64_tr_b16 v[86:87], v10 offset:19200
  v_mfma_f32_16x16x32_bf16 v[24:27], v[44:47], v[52:55], v[24:27]
  ds_read_b64_tr_b16 v[88:89], v11 offset:18432
  v_mfma_f32_16x16x32_bf16 v[28:31], v[44:47], v[56:59], v[28:31]
  ds_read_b64_tr_b16 v[90:91], v11 offset:19200
  v_mfma_f32_16x16x32_bf16 v[32:35], v[48:51], v[52:55], v[32:35]
  ds_read_b128 v[92:95], v123 offset:40960
  v_mfma_f32_16x16x32_bf16 v[36:39], v[48:51], v[56:59], v[36:39]
  ds_read_b128 v[96:99], v123 offset:43008
  s_barrier
  s_waitcnt lgkmcnt(8)
  v_mfma_f32_16x16x32_bf16 v[16:19], v[60:63], v[72:75], v[16:19]
  ds_read_b64_tr_b16 v[40:41], v9 offset:24576
  ds_read_b64_tr_b16 v[42:43], v9 offset:25344
  v_mfma_f32_16x16x32_bf16 v[20:23], v[60:63], v[76:79], v[20:23]
  ds_read_b64_tr_b16 v[44:45], v10 offset:24576
  ds_read_b64_tr_b16 v[46:47], v10 offset:25344
  v_mfma_f32_16x16x32_bf16 v[24:27], v[64:67], v[72:75], v[24:27]
  ds_read_b64_tr_b16 v[48:49], v11 offset:24576
  v_mfma_f32_16x16x32_bf16 v[28:31], v[64:67], v[76:79], v[28:31]
  ds_read_b64_tr_b16 v[50:51], v11 offset:25344
  v_mfma_f32_16x16x32_bf16 v[32:35], v[68:71], v[72:75], v[32:35]
  ds_read_b128 v[52:55], v122 offset:49152
  v_mfma_f32_16x16x32_bf16 v[36:39], v[68:71], v[76:79], v[36:39]
  ds_read_b128 v[56:59], v122 offset:51200
  s_waitcnt lgkmcnt(8)
  v_mfma_f32_16x16x32_bf16 v[16:19], v[80:83], v[92:95], v[16:19]
  ds_read_b64_tr_b16 v[60:61], v9 offset:30720
  ds_read_b64_tr_b16 v[62:63], v9 offset:31488
  v_mfma_f32_16x16x32_bf16 v[20:23], v[80:83], v[96:99], v[20:23]
  ds_read_b64_tr_b16 v[64:65], v10 offset:30720
  ds_read_b64_tr_b16 v[66:67], v10 offset:31488
  v_mfma_f32_16x16x32_bf16 v[24:27], v[84:87], v[92:95], v[24:27]
  ds_read_b64_tr_b16 v[68:69], v11 offset:30720
  v_mfma_f32_16x16x32_bf16 v[28:31], v[84:87], v[96:99], v[28:31]
  ds_read_b64_tr_b16 v[70:71], v11 offset:31488
  v_mfma_f32_16x16x32_bf16 v[32:35], v[88:91], v[92:95], v[32:35]
  ds_read_b128 v[72:75], v123 offset:49152
  v_mfma_f32_16x16x32_bf16 v[36:39], v[88:91], v[96:99], v[36:39]
  ds_read_b128 v[76:79], v123 offset:51200
  s_barrier
  s_waitcnt lgkmcnt(8)
  v_mfma_f32_16x16x32_bf16 v[16:19], v[40:43], v[52:55], v[16:19]
  ds_read_b64_tr_b16 v[80:81], v9 offset:36864
  ds_read_b64_tr_b16 v[82:83], v9 offset:37632
  v_mfma_f32_16x16x32_bf16 v[20:23], v[40:43], v[56:59], v[20:23]
  ds_read_b64_tr_b16 v[84:85], v10 offset:36864
  ds_read_b64_tr_b16 v[86:87], v10 offset:37632
  v_mfma_f32_16x16x32_bf16 v[24:27], v[44:47], v[52:55], v[24:27]
  ds_read_b64_tr_b16 v[88:89], v11 offset:36864
  v_mfma_f32_16x16x32_bf16 v[28:31], v[44:47], v[56:59], v[28:31]
  ds_read_b64_tr_b16 v[90:91], v11 offset:37632
  v_mfma_f32_16x16x32_bf16 v[32:35], v[48:51], v[52:55], v[32:35]
  ds_read_b128 v[92:95], v122 offset:57344
  v_mfma_f32_16x16x32_bf16 v[36:39], v[48:51], v[56:59], v[36:39]
  ds_read_b128 v[96:99], v122 offset:59392
  s_waitcnt lgkmcnt(8)
  v_mfma_f32_16x16x32_bf16 v[16:19], v[60:63], v[72:75], v[16:19]
  ds_read_b64_tr_b16 v[40:41], v9 offset:43008
  ds_read_b64_tr_b16 v[42:43], v9 offset:43776
  v_mfma_f32_16x16x32_bf16 v[20:23], v[60:63], v[76:79], v[20:23]
  ds_read_b64_tr_b16 v[44:45], v10 offset:43008
  ds_read_b64_tr_b16 v[46:47], v10 offset:43776
  v_mfma_f32_16x16x32_bf16 v[24:27], v[64:67], v[72:75], v[24:27]
  ds_read_b64_tr_b16 v[48:49], v11 offset:43008
  v_mfma_f32_16x16x32_bf16 v[28:31], v[64:67], v[76:79], v[28:31]
  ds_read_b64_tr_b16 v[50:51], v11 offset:43776
  v_mfma_f32_16x16x32_bf16 v[32:35], v[68:71], v[72:75], v[32:35]
  ds_read_b128 v[52:55], v123 offset:57344
  v_mfma_f32_16x16x32_bf16 v[36:39], v[68:71], v[76:79], v[36:39]
  ds_read_b128 v[56:59], v123 offset:59392
  s_waitcnt lgkmcnt(8)
  v_mfma_f32_16x16x32_bf16 v[16:19], v[80:83], v[92:95], v[16:19]
  v_mfma_f32_16x16x32_bf16 v[20:23], v[80:83], v[96:99], v[20:23]
  v_mfma_f32_16x16x32_bf16 v[24:27], v[84:87], v[92:95], v[24:27]
  v_mfma_f32_16x16x32_bf16 v[28:31], v[84:87], v[96:99], v[28:31]
  v_mfma_f32_16x16x32_bf16 v[32:35], v[88:91], v[92:95], v[32:35]
  v_mfma_f32_16x16x32_bf16 v[36:39], v[88:91], v[96:99], v[36:39]
  s_waitcnt lgkmcnt(0)
  v_mfma_f32_16x16x32_bf16 v[16:19], v[40:43], v[52:55], v[16:19]
  v_mfma_f32_16x16x32_bf16 v[20:23], v[40:43], v[56:59], v[20:23]
  v_mfma_f32_16x16x32_bf16 v[24:27], v[44:47], v[52:55], v[24:27]
  v_mfma_f32_16x16x32_bf16 v[28:31], v[44:47], v[56:59], v[28:31]
  v_mfma_f32_16x16x32_bf16 v[32:35], v[48:51], v[52:55], v[32:35]
  v_mfma_f32_16x16x32_bf16 v[36:39], v[48:51], v[56:59], v[36:39]
  s_waitcnt vmcnt(0)
  s_nop 7
  v_lshlrev_b32 v120, 16, v120
  v_lshlrev_b32 v121, 16, v121
  s_movk_i32 s48, 1408
  v_mul_lo_u32 v105, v104, s48
  v_lshl_add_u32 v105, v14, 3, v105
  s_add_u32 s31, s31, 12582912
  s_cmp_lt_u32 s29, 3
  s_cselect_b32 s50, 6, 5
  v_lshlrev_b32 v60, 16, v108
  v_and_b32 v61, 0xffff0000, v108
  v_lshlrev_b32 v62, 16, v109
  v_and_b32 v63, 0xffff0000, v109
  v_add_f32 v16, v16, v120
  v_add_f32 v17, v17, v120
  v_add_f32 v18, v18, v120
  v_add_f32 v19, v19, v120
  v_mul_f32 v16, v16, v60
  v_mul_f32 v17, v17, v61
  v_mul_f32 v18, v18, v62
  v_mul_f32 v19, v19, v63
  v_cvt_pk_bf16_f32 v16, v16, v17
  v_cvt_pk_bf16_f32 v17, v18, v19
  s_add_u32 s49, s31, 0
  buffer_store_dwordx2 v[16:17], v105, s[20:23], s49 offen offset:0
  v_lshlrev_b32 v60, 16, v114
  v_and_b32 v61, 0xffff0000, v114
  v_lshlrev_b32 v62, 16, v115
  v_and_b32 v63, 0xffff0000, v115
  v_add_f32 v20, v20, v121
  v_add_f32 v21, v21, v121
  v_add_f32 v22, v22, v121
  v_add_f32 v23, v23, v121
  v_mul_f32 v20, v20, v60
  v_mul_f32 v21, v21, v61
  v_mul_f32 v22, v22, v62
  v_mul_f32 v23, v23, v63
  v_cvt_pk_bf16_f32 v20, v20, v21
  v_cvt_pk_bf16_f32 v21, v22, v23
  s_add_u32 s49, s31, 22528
  buffer_store_dwordx2 v[20:21], v105, s[20:23], s49 offen offset:0
k2e_52:
  v_lshlrev_b32 v60, 16, v110
  v_and_b32 v61, 0xffff0000, v110
  v_lshlrev_b32 v62, 16, v111
  v_and_b32 v63, 0xffff0000, v111
  v_add_f32 v24, v24, v120
  v_add_f32 v25, v25, v120
  v_add_f32 v26, v26, v120
  v_add_f32 v27, v27, v120
  v_mul_f32 v24, v24, v60
  v_mul_f32 v25, v25, v61
  v_mul_f32 v26, v26, v62
  v_mul_f32 v27, v27, v63
  v_cvt_pk_bf16_f32 v24, v24, v25
  v_cvt_pk_bf16_f32 v25, v26, v27
  s_add_u32 s49, s31, 0
  buffer_store_dwordx2 v[24:25], v105, s[20:23], s49 offen offset:32
  v_lshlrev_b32 v60, 16, v116
  v_and_b32 v61, 0xffff0000, v116
  v_lshlrev_b32 v62, 16, v117
  v_and_b32 v63, 0xffff0000, v117
  v_add_f32 v28, v28, v121
  v_add_f32 v29, v29, v121
  v_add_f32 v30, v30, v121
  v_add_f32 v31, v31, v121
  v_mul_f32 v28, v28, v60
  v_mul_f32 v29, v29, v61
  v_mul_f32 v30, v30, v62
  v_mul_f32 v31, v31, v63
  v_cvt_pk_bf16_f32 v28, v28, v29
  v_cvt_pk_bf16_f32 v29, v30, v31
  s_add_u32 s49, s31, 22528
  buffer_store_dwordx2 v[28:29], v105, s[20:23], s49 offen offset:32
k2e_53:
  s_mul_i32 s49, s25, 3
  s_add_u32 s49, s49, 2
  s_cmp_lt_u32 s49, s50
  s_cbranch_scc1 k2v_55
  s_cmp_eq_u32 s29, 7
  s_cbranch_scc0 k2e_54
  v_mov_b32 v32, 0
  v_mov_b32 v33, 0
  s_add_u32 s49, s31, 0
  buffer_store_dwordx2 v[32:33], v105, s[20:23], s49 offen offset:64
  v_mov_b32 v36, 0
  v_mov_b32 v37, 0
  s_add_u32 s49, s31, 22528
  buffer_store_dwordx2 v[36:37], v105, s[20:23], s49 offen offset:64
  s_branch k2e_54
k2v_55:
  v_lshlrev_b32 v60, 16, v112
  v_and_b32 v61, 0xffff0000, v112
  v_lshlrev_b32 v62, 16, v113
  v_and_b32 v63, 0xffff0000, v113
  v_add_f32 v32, v32, v120
  v_add_f32 v33, v33, v120
  v_add_f32 v34, v34, v120
  v_add_f32 v35, v35, v120
  v_mul_f32 v32, v32, v60
  v_mul_f32 v33, v33, v61
  v_mul_f32 v34, v34, v62
  v_mul_f32 v35, v35, v63
  v_cvt_pk_bf16_f32 v32, v32, v33
  v_cvt_pk_bf16_f32 v33, v34, v35
  s_add_u32 s49, s31, 0
  buffer_store_dwordx2 v[32:33], v105, s[20:23], s49 offen offset:64
  v_lshlrev_b32 v60, 16, v118
  v_and_b32 v61, 0xffff0000, v118
  v_lshlrev_b32 v62, 16, v119
  v_and_b32 v63, 0xffff0000, v119
  v_add_f32 v36, v36, v121
  v_add_f32 v37, v37, v121
  v_add_f32 v38, v38, v121
  v_add_f32 v39, v39, v121
  v_mul_f32 v36, v36, v60
  v_mul_f32 v37, v37, v61
  v_mul_f32 v38, v38, v62
  v_mul_f32 v39, v39, v63
  v_cvt_pk_bf16_f32 v36, v36, v37
  v_cvt_pk_bf16_f32 v37, v38, v39
  s_add_u32 s49, s31, 22528
  buffer_store_dwordx2 v[36:37], v105, s[20:23], s49 offen offset:64
k2e_54:
  s_endpgm
k2_prod:
  s_sub_u32 s25, s24, 4
  v_lshrrev_b32 v10, 3, v1
  v_and_b32 v11, 7, v1
  v_xor_b32 v11, v11, v10
  v_lshlrev_b32 v11, 4, v11
  v_lshl_add_u32 v10, v10, 12, v11
  s_lshl_b32 s48, s28, 18
  s_lshl_b32 s49, s25, 15
  s_add_u32 s33, s48, s49
  s_lshl_b32 s35, s25, 10
  v_add_u32 v2, 0, v1
  v_mul_u32_u24 v3, 0x5556, v2
  v_lshrrev_b32 v3, 18, v3
  v_mul_u32_u24 v4, 12, v3
  v_sub_u32 v4, v2, v4
  v_bfe_u32 v5, v3, 3, 1
  v_lshlrev_b32 v5, 1, v5
  v_xor_b32 v4, v4, v5
  v_mul_u32_u24 v3, 192, v3
  v_lshl_add_u32 v20, v4, 4, v3
  v_add_u32 v2, 64, v1
  v_mul_u32_u24 v3, 0x5556, v2
  v_lshrrev_b32 v3, 18, v3
  v_mul_u32_u24 v4, 12, v3
  v_sub_u32 v4, v2, v4
  v_bfe_u32 v5, v3, 3, 1
  v_lshlrev_b32 v5, 1, v5
  v_xor_b32 v4, v4, v5
  v_mul_u32_u24 v3, 192, v3
  v_lshl_add_u32 v21, v4, 4, v3
  v_add_u32 v2, 128, v1
  v_mul_u32_u24 v3, 0x5556, v2
  v_lshrrev_b32 v3, 18, v3
  v_mul_u32_u24 v4, 12, v3
  v_sub_u32 v4, v2, v4
  v_bfe_u32 v5, v3, 3, 1
  v_lshlrev_b32 v5, 1, v5
  v_xor_b32 v4, v4, v5
  v_mul_u32_u24 v3, 192, v3
  v_lshl_add_u32 v22, v4, 4, v3
  s_mul_i32 s48, s29, 393216
  s_mul_i32 s49, s25, 3072
  s_add_u32 s32, s48, s49
  s_add_u32 s32, s32, 20971520
  s_mul_i32 s36, s25, 3072
  s_add_u32 s36, s36, 65536
  s_mul_i32 s37, s28, 0
  s_add_u32 s38, s37, 0
  s_and_b32 s38, s38, 31
  s_mul_i32 s39, s38, 12288
  s_add_u32 s39, s39, s32
  s_lshl_b32 s38, s38, 7
  s_add_u32 s38, s38, s33
  s_add_u32 m0, s36, 0
  s_nop 0
  buffer_load_dwordx4 v20, s[20:23], s39 offen lds
  s_add_u32 m0, s36, 1024
  s_nop 0
  buffer_load_dwordx4 v21, s[20:23], s39 offen lds
  s_add_u32 m0, s36, 2048
  s_nop 0
  buffer_load_dwordx4 v22, s[20:23], s39 offen lds
  s_add_u32 m0, s35, 0
  s_add_u32 s42, s38, 0
  buffer_load_dwordx4 v10, s[12:15], s42 offen lds
  s_add_u32 m0, s35, 4096
  s_add_u32 s42, s38, 131072
  buffer_load_dwordx4 v10, s[12:15], s42 offen lds
  s_add_u32 s38, s37, 1
  s_and_b32 s38, s38, 31
  s_mul_i32 s39, s38, 12288
  s_add_u32 s39, s39, s32
  s_lshl_b32 s38, s38, 7
  s_add_u32 s38, s38, s33
  s_add_u32 m0, s36, 12288
  s_nop 0
  buffer_load_dwordx4 v20, s[20:23], s39 offen lds
  s_add_u32 m0, s36, 13312
  s_nop 0
  buffer_load_dwordx4 v21, s[20:23], s39 offen lds
  s_add_u32 m0, s36, 14336
  s_nop 0
  buffer_load_dwordx4 v22, s[20:23], s39 offen lds
  s_add_u32 m0, s35, 8192
  s_add_u32 s42, s38, 0
  buffer_load_dwordx4 v10, s[12:15], s42 offen lds
  s_add_u32 m0, s35, 12288
  s_add_u32 s42, s38, 131072
  buffer_load_dwordx4 v10, s[12:15], s42 offen lds
  s_waitcnt vmcnt(5)
  s_barrier
  s_add_u32 s38, s37, 2
  s_and_b32 s38, s38, 31
  s_mul_i32 s39, s38, 12288
  s_add_u32 s39, s39, s32
  s_lshl_b32 s38, s38, 7
  s_add_u32 s38, s38, s33
  s_add_u32 m0, s36, 24576
  s_nop 0
  buffer_load_dwordx4 v20, s[20:23], s39 offen lds
  s_add_u32 m0, s36, 25600
  s_nop 0
  buffer_load_dwordx4 v21, s[20:23], s39 offen lds
  s_add_u32 m0, s36, 26624
  s_nop 0
  buffer_load_dwordx4 v22, s[20:23], s39 offen lds
  s_add_u32 m0, s35, 16384
  s_add_u32 s42, s38, 0
  buffer_load_dwordx4 v10, s[12:15], s42 offen lds
  s_add_u32 m0, s35, 20480
  s_add_u32 s42, s38, 131072
  buffer_load_dwordx4 v10, s[12:15], s42 offen lds
  s_add_u32 s38, s37, 3
  s_and_b32 s38, s38, 31
  s_mul_i32 s39, s38, 12288
  s_add_u32 s39, s39, s32
  s_lshl_b32 s38, s38, 7
  s_add_u32 s38, s38, s33
  s_add_u32 m0, s36, 36864
  s_nop 0
  buffer_load_dwordx4 v20, s[20:23], s39 offen lds
  s_add_u32 m0, s36, 37888
  s_nop 0
  buffer_load_dwordx4 v21, s[20:23], s39 offen lds
  s_add_u32 m0, s36, 38912
  s_nop 0
  buffer_load_dwordx4 v22, s[20:23], s39 offen lds
  s_add_u32 m0, s35, 24576
  s_add_u32 s42, s38, 0
  buffer_load_dwordx4 v10, s[12:15], s42 offen lds
  s_add_u32 m0, s35, 28672
  s_add_u32 s42, s38, 131072
  buffer_load_dwordx4 v10, s[12:15], s42 offen lds
  s_waitcnt vmcnt(10)
  s_barrier
  s_add_u32 s38, s37, 4
  s_and_b32 s38, s38, 31
  s_mul_i32 s39, s38, 12288
  s_add_u32 s39, s39, s32
  s_lshl_b32 s38, s38, 7
  s_add_u32 s38, s38, s33
  s_add_u32 m0, s36, 49152
  s_nop 0
  buffer_load_dwordx4 v20, s[20:23], s39 offen lds
  s_add_u32 m0, s36, 50176
  s_nop 0
  buffer_load_dwordx4 v21, s[20:23], s39 offen lds
  s_add_u32 m0, s36, 51200
  s_nop 0
  buffer_load_dwordx4 v22, s[20:23], s39 offen lds
  s_add_u32 m0, s35, 32768
  s_add_u32 s42, s38, 0
  buffer_load_dwordx4 v10, s[12:15], s42 offen lds
  s_add_u32 m0, s35, 36864
  s_add_u32 s42, s38, 131072
  buffer_load_dwordx4 v10, s[12:15], s42 offen lds
  s_add_u32 s38, s37, 5
  s_and_b32 s38, s38, 31
  s_mul_i32 s39, s38, 12288
  s_add_u32 s39, s39, s32
  s_lshl_b32 s38, s38, 7
  s_add_u32 s38, s38, s33
  s_add_u32 m0, s36, 61440
  s_nop 0
  buffer_load_dwordx4 v20, s[20:23], s39 offen lds
  s_add_u32 m0, s36, 62464
  s_nop 0
  buffer_load_dwordx4 v21, s[20:23], s39 offen lds
  s_add_u32 m0, s36, 63488
  s_nop 0
  buffer_load_dwordx4 v22, s[20:23], s39 offen lds
  s_add_u32 m0, s35, 40960
  s_add_u32 s42, s38, 0
  buffer_load_dwordx4 v10, s[12:15], s42 offen lds
  s_add_u32 m0, s35, 45056
  s_add_u32 s42, s38, 131072
  buffer_load_dwordx4 v10, s[12:15], s42 offen lds
  s_waitcnt vmcnt(15)
  s_barrier
  s_add_u32 s38, s37, 6
  s_and_b32 s38, s38, 31
  s_mul_i32 s39, s38, 12288
  s_add_u32 s39, s39, s32
  s_lshl_b32 s38, s38, 7
  s_add_u32 s38, s38, s33
  s_add_u32 m0, s36, 73728
  s_nop 0
  buffer_load_dwordx4 v20, s[20:23], s39 offen lds
  s_add_u32 m0, s36, 74752
  s_nop 0
  buffer_load_dwordx4 v21, s[20:23], s39 offen lds
  s_add_u32 m0, s36, 75776
  s_nop 0
  buffer_load_dwordx4 v22, s[20:23], s39 offen lds
  s_add_u32 m0, s35, 49152
  s_add_u32 s42, s38, 0
  buffer_load_dwordx4 v10, s[12:15], s42 offen lds
  s_add_u32 m0, s35, 53248
  s_add_u32 s42, s38, 131072
  buffer_load_dwordx4 v10, s[12:15], s42 offen lds
  s_add_u32 s38, s37, 7
  s_and_b32 s38, s38, 31
  s_mul_i32 s39, s38, 12288
  s_add_u32 s39, s39, s32
  s_lshl_b32 s38, s38, 7
  s_add_u32 s38, s38, s33
  s_add_u32 m0, s36, 86016
  s_nop 0
  buffer_load_dwordx4 v20, s[20:23], s39 offen lds
  s_add_u32 m0, s36, 87040
  s_nop 0
  buffer_load_dwordx4 v21, s[20:23], s39 offen lds
  s_add_u32 m0, s36, 88064
  s_nop 0
  buffer_load_dwordx4 v22, s[20:23], s39 offen lds
  s_add_u32 m0, s35, 57344
  s_add_u32 s42, s38, 0
  buffer_load_dwordx4 v10, s[12:15], s42 offen lds
  s_add_u32 m0, s35, 61440
  s_add_u32 s42, s38, 131072
  buffer_load_dwordx4 v10, s[12:15], s42 offen lds
  s_waitcnt vmcnt(20)
  s_barrier
  s_add_u32 s38, s37, 8
  s_and_b32 s38, s38, 31
  s_mul_i32 s39, s38, 12288
  s_add_u32 s39, s39, s32
  s_lshl_b32 s38, s38, 7
  s_add_u32 s38, s38, s33
  s_add_u32 m0, s36, 0
  s_nop 0
  buffer_load_dwordx4 v20, s[20:23], s39 offen lds
  s_add_u32 m0, s36, 1024
  s_nop 0
  buffer_load_dwordx4 v21, s[20:23], s39 offen lds
  s_add_u32 m0, s36, 2048
  s_nop 0
  buffer_load_dwordx4 v22, s[20:23], s39 offen lds
  s_add_u32 m0, s35, 0
  s_add_u32 s42, s38, 0
  buffer_load_dwordx4 v10, s[12:15], s42 offen lds
  s_add_u32 m0, s35, 4096
  s_add_u32 s42, s38, 131072
  buffer_load_dwordx4 v10, s[12:15], s42 offen lds
  s_add_u32 s38, s37, 9
  s_and_b32 s38, s38, 31
  s_mul_i32 s39, s38, 12288
  s_add_u32 s39, s39, s32
  s_lshl_b32 s38, s38, 7
  s_add_u32 s38, s38, s33
  s_add_u32 m0, s36, 12288
  s_nop 0
  buffer_load_dwordx4 v20, s[20:23], s39 offen lds
  s_add_u32 m0, s36, 13312
  s_nop 0
  buffer_load_dwordx4 v21, s[20:23], s39 offen lds
  s_add_u32 m0, s36, 14336
  s_nop 0
  buffer_load_dwordx4 v22, s[20:23], s39 offen lds
  s_add_u32 m0, s35, 8192
  s_add_u32 s42, s38, 0
  buffer_load_dwordx4 v10, s[12:15], s42 offen lds
  s_add_u32 m0, s35, 12288
  s_add_u32 s42, s38, 131072
  buffer_load_dwordx4 v10, s[12:15], s42 offen lds
  s_waitcnt vmcnt(25)
  s_barrier
  s_add_u32 s38, s37, 10
  s_and_b32 s38, s38, 31
  s_mul_i32 s39, s38, 12288
  s_add_u32 s39, s39, s32
  s_lshl_b32 s38, s38, 7
  s_add_u32 s38, s38, s33
  s_add_u32 m0, s36, 24576
  s_nop 0
  buffer_load_dwordx4 v20, s[20:23], s39 offen lds
  s_add_u32 m0, s36, 25600
  s_nop 0
  buffer_load_dwordx4 v21, s[20:23], s39 offen lds
  s_add_u32 m0, s36, 26624
  s_nop 0
  buffer_load_dwordx4 v22, s[20:23], s39 offen lds
  s_add_u32 m0, s35, 16384
  s_add_u32 s42, s38, 0
  buffer_load_dwordx4 v10, s[12:15], s42 offen lds
  s_add_u32 m0, s35, 20480
  s_add_u32 s42, s38, 131072
  buffer_load_dwordx4 v10, s[12:15], s42 offen lds
  s_waitcnt vmcnt(25)
  s_barrier
  s_add_u32 s38, s37, 11
  s_and_b32 s38, s38, 31
  s_mul_i32 s39, s38, 12288
  s_add_u32 s39, s39, s32
  s_lshl_b32 s38, s38, 7
  s_add_u32 s38, s38, s33
  s_add_u32 m0, s36, 36864
  s_nop 0
  buffer_load_dwordx4 v20, s[20:23], s39 offen lds
  s_add_u32 m0, s36, 37888
  s_nop 0
  buffer_load_dwordx4 v21, s[20:23], s39 offen lds
  s_add_u32 m0, s36, 38912
  s_nop 0
  buffer_load_dwordx4 v22, s[20:23], s39 offen lds
  s_add_u32 m0, s35, 24576
  s_add_u32 s42, s38, 0
  buffer_load_dwordx4 v10, s[12:15], s42 offen lds
  s_add_u32 m0, s35, 28672
  s_add_u32 s42, s38, 131072
  buffer_load_dwordx4 v10, s[12:15], s42 offen lds
  s_waitcnt vmcnt(25)
  s_barrier
  s_add_u32 s38, s37, 12
  s_and_b32 s38, s38, 31
  s_mul_i32 s39, s38, 12288
  s_add_u32 s39, s39, s32
  s_lshl_b32 s38, s38, 7
  s_add_u32 s38, s38, s33
  s_add_u32 m0, s36, 49152
  s_nop 0
  buffer_load_dwordx4 v20, s[20:23], s39 offen lds
  s_add_u32 m0, s36, 50176
  s_nop 0
  buffer_load_dwordx4 v21, s[20:23], s39 offen lds
  s_add_u32 m0, s36, 51200
  s_nop 0
  buffer_load_dwordx4 v22, s[20:23], s39 offen lds
  s_add_u32 m0, s35, 32768
  s_add_u32 s42, s38, 0
  buffer_load_dwordx4 v10, s[12:15], s42 offen lds
  s_add_u32 m0, s35, 36864
  s_add_u32 s42, s38, 131072
  buffer_load_dwordx4 v10, s[12:15], s42 offen lds
  s_waitcnt vmcnt(25)
  s_barrier
  s_add_u32 s38, s37, 13
  s_and_b32 s38, s38, 31
  s_mul_i32 s39, s38, 12288
  s_add_u32 s39, s39, s32
  s_lshl_b32 s38, s38, 7
  s_add_u32 s38, s38, s33
  s_add_u32 m0, s36, 61440
  s_nop 0
  buffer_load_dwordx4 v20, s[20:23], s39 offen lds
  s_add_u32 m0, s36, 62464
  s_nop 0
  buffer_load_dwordx4 v21, s[20:23], s39 offen lds
  s_add_u32 m0, s36, 63488
  s_nop 0
  buffer_load_dwordx4 v22, s[20:23], s39 offen lds
  s_add_u32 m0, s35, 40960
  s_add_u32 s42, s38, 0
  buffer_load_dwordx4 v10, s[12:15], s42 offen lds
  s_add_u32 m0, s35, 45056
  s_add_u32 s42, s38, 131072
  buffer_load_dwordx4 v10, s[12:15], s42 offen lds
  s_waitcnt vmcnt(25)
  s_barrier
  s_add_u32 s38, s37, 14
  s_and_b32 s38, s38, 31
  s_mul_i32 s39, s38, 12288
  s_add_u32 s39, s39, s32
  s_lshl_b32 s38, s38, 7
  s_add_u32 s38, s38, s33
  s_add_u32 m0, s36, 73728
  s_nop 0
  buffer_load_dwordx4 v20, s[20:23], s39 offen lds
  s_add_u32 m0, s36, 74752
  s_nop 0
  buffer_load_dwordx4 v21, s[20:23], s39 offen lds
  s_add_u32 m0, s36, 75776
  s_nop 0
  buffer_load_dwordx4 v22, s[20:23], s39 offen lds
  s_add_u32 m0, s35, 49152
  s_add_u32 s42, s38, 0
  buffer_load_dwordx4 v10, s[12:15], s42 offen lds
  s_add_u32 m0, s35, 53248
  s_add_u32 s42, s38, 131072
  buffer_load_dwordx4 v10, s[12:15], s42 offen lds
  s_waitcnt vmcnt(25)
  s_barrier
  s_add_u32 s38, s37, 15
  s_and_b32 s38, s38, 31
  s_mul_i32 s39, s38, 12288
  s_add_u32 s39, s39, s32
  s_lshl_b32 s38, s38, 7
  s_add_u32 s38, s38, s33
  s_add_u32 m0, s36, 86016
  s_nop 0
  buffer_load_dwordx4 v20, s[20:23], s39 offen lds
  s_add_u32 m0, s36, 87040
  s_nop 0
  buffer_load_dwordx4 v21, s[20:23], s39 offen lds
  s_add_u32 m0, s36, 88064
  s_nop 0
  buffer_load_dwordx4 v22, s[20:23], s39 offen lds
  s_add_u32 m0, s35, 57344
  s_add_u32 s42, s38, 0
  buffer_load_dwordx4 v10, s[12:15], s42 offen lds
  s_add_u32 m0, s35, 61440
  s_add_u32 s42, s38, 131072
  buffer_load_dwordx4 v10, s[12:15], s42 offen lds
  s_waitcnt vmcnt(25)
  s_barrier
  s_add_u32 s38, s37, 16
  s_and_b32 s38, s38, 31
  s_mul_i32 s39, s38, 12288
  s_add_u32 s39, s39, s32
  s_lshl_b32 s38, s38, 7
  s_add_u32 s38, s38, s33
  s_add_u32 m0, s36, 0
  s_nop 0
  buffer_load_dwordx4 v20, s[20:23], s39 offen lds
  s_add_u32 m0, s36, 1024
  s_nop 0
  buffer_load_dwordx4 v21, s[20:23], s39 offen lds
  s_add_u32 m0, s36, 2048
  s_nop 0
  buffer_load_dwordx4 v22, s[20:23], s39 offen lds
  s_add_u32 m0, s35, 0
  s_add_u32 s42, s38, 0
  buffer_load_dwordx4 v10, s[12:15], s42 offen lds
  s_add_u32 m0, s35, 4096
  s_add_u32 s42, s38, 131072
  buffer_load_dwordx4 v10, s[12:15], s42 offen lds
  s_waitcnt vmcnt(25)
  s_barrier
  s_add_u32 s38, s37, 17
  s_and_b32 s38, s38, 31
  s_mul_i32 s39, s38, 12288
  s_add_u32 s39, s39, s32
  s_lshl_b32 s38, s38, 7
  s_add_u32 s38, s38, s33
  s_add_u32 m0, s36, 12288
  s_nop 0
  buffer_load_dwordx4 v20, s[20:23], s39 offen lds
  s_add_u32 m0, s36, 13312
  s_nop 0
  buffer_load_dwordx4 v21, s[20:23], s39 offen lds
  s_add_u32 m0, s36, 14336
  s_nop 0
  buffer_load_dwordx4 v22, s[20:23], s39 offen lds
  s_add_u32 m0, s35, 8192
  s_add_u32 s42, s38, 0
  buffer_load_dwordx4 v10, s[12:15], s42 offen lds
  s_add_u32 m0, s35, 12288
  s_add_u32 s42, s38, 131072
  buffer_load_dwordx4 v10, s[12:15], s42 offen lds
  s_waitcnt vmcnt(25)
  s_barrier
  s_add_u32 s38, s37, 18
  s_and_b32 s38, s38, 31
  s_mul_i32 s39, s38, 12288
  s_add_u32 s39, s39, s32
  s_lshl_b32 s38, s38, 7
  s_add_u32 s38, s38, s33
  s_add_u32 m0, s36, 24576
  s_nop 0
  buffer_load_dwordx4 v20, s[20:23], s39 offen lds
  s_add_u32 m0, s36, 25600
  s_nop 0
  buffer_load_dwordx4 v21, s[20:23], s39 offen lds
  s_add_u32 m0, s36, 26624
  s_nop 0
  buffer_load_dwordx4 v22, s[20:23], s39 offen lds
  s_add_u32 m0, s35, 16384
  s_add_u32 s42, s38, 0
  buffer_load_dwordx4 v10, s[12:15], s42 offen lds
  s_add_u32 m0, s35, 20480
  s_add_u32 s42, s38, 131072
  buffer_load_dwordx4 v10, s[12:15], s42 offen lds
  s_waitcnt vmcnt(25)
  s_barrier
  s_add_u32 s38, s37, 19
  s_and_b32 s38, s38, 31
  s_mul_i32 s39, s38, 12288
  s_add_u32 s39, s39, s32
  s_lshl_b32 s38, s38, 7
  s_add_u32 s38, s38, s33
  s_add_u32 m0, s36, 36864
  s_nop 0
  buffer_load_dwordx4 v20, s[20:23], s39 offen lds
  s_add_u32 m0, s36, 37888
  s_nop 0
  buffer_load_dwordx4 v21, s[20:23], s39 offen lds
  s_add_u32 m0, s36, 38912
  s_nop 0
  buffer_load_dwordx4 v22, s[20:23], s39 offen lds
  s_add_u32 m0, s35, 24576
  s_add_u32 s42, s38, 0
  buffer_load_dwordx4 v10, s[12:15], s42 offen lds
  s_add_u32 m0, s35, 28672
  s_add_u32 s42, s38, 131072
  buffer_load_dwordx4 v10, s[12:15], s42 offen lds
  s_waitcnt vmcnt(25)
  s_barrier
  s_add_u32 s38, s37, 20
  s_and_b32 s38, s38, 31
  s_mul_i32 s39, s38, 12288
  s_add_u32 s39, s39, s32
  s_lshl_b32 s38, s38, 7
  s_add_u32 s38, s38, s33
  s_add_u32 m0, s36, 49152
  s_nop 0
  buffer_load_dwordx4 v20, s[20:23], s39 offen lds
  s_add_u32 m0, s36, 50176
  s_nop 0
  buffer_load_dwordx4 v21, s[20:23], s39 offen lds
  s_add_u32 m0, s36, 51200
  s_nop 0
  buffer_load_dwordx4 v22, s[20:23], s39 offen lds
  s_add_u32 m0, s35, 32768
  s_add_u32 s42, s38, 0
  buffer_load_dwordx4 v10, s[12:15], s42 offen lds
  s_add_u32 m0, s35, 36864
  s_add_u32 s42, s38, 131072
  buffer_load_dwordx4 v10, s[12:15], s42 offen lds
  s_waitcnt vmcnt(25)
  s_barrier
  s_add_u32 s38, s37, 21
  s_and_b32 s38, s38, 31
  s_mul_i32 s39, s38, 12288
  s_add_u32 s39, s39, s32
  s_lshl_b32 s38, s38, 7
  s_add_u32 s38, s38, s33
  s_add_u32 m0, s36, 61440
  s_nop 0
  buffer_load_dwordx4 v20, s[20:23], s39 offen lds
  s_add_u32 m0, s36, 62464
  s_nop 0
  buffer_load_dwordx4 v21, s[20:23], s39 offen lds
  s_add_u32 m0, s36, 63488
  s_nop 0
  buffer_load_dwordx4 v22, s[20:23], s39 offen lds
  s_add_u32 m0, s35, 40960
  s_add_u32 s42, s38, 0
  buffer_load_dwordx4 v10, s[12:15], s42 offen lds
  s_add_u32 m0, s35, 45056
  s_add_u32 s42, s38, 131072
  buffer_load_dwordx4 v10, s[12:15], s42 offen lds
  s_waitcnt vmcnt(25)
  s_barrier
  s_add_u32 s38, s37, 22
  s_and_b32 s38, s38, 31
  s_mul_i32 s39, s38, 12288
  s_add_u32 s39, s39, s32
  s_lshl_b32 s38, s38, 7
  s_add_u32 s38, s38, s33
  s_add_u32 m0, s36, 73728
  s_nop 0
  buffer_load_dwordx4 v20, s[20:23], s39 offen lds
  s_add_u32 m0, s36, 74752
  s_nop 0
  buffer_load_dwordx4 v21, s[20:23], s39 offen lds
  s_add_u32 m0, s36, 75776
  s_nop 0
  buffer_load_dwordx4 v22, s[20:23], s39 offen lds
  s_add_u32 m0, s35, 49152
  s_add_u32 s42, s38, 0
  buffer_load_dwordx4 v10, s[12:15], s42 offen lds
  s_add_u32 m0, s35, 53248
  s_add_u32 s42, s38, 131072
  buffer_load_dwordx4 v10, s[12:15], s42 offen lds
  s_waitcnt vmcnt(25)
  s_barrier
  s_add_u32 s38, s37, 23
  s_and_b32 s38, s38, 31
  s_mul_i32 s39, s38, 12288
  s_add_u32 s39, s39, s32
  s_lshl_b32 s38, s38, 7
  s_add_u32 s38, s38, s33
  s_add_u32 m0, s36, 86016
  s_nop 0
  buffer_load_dwordx4 v20, s[20:23], s39 offen lds
  s_add_u32 m0, s36, 87040
  s_nop 0
  buffer_load_dwordx4 v21, s[20:23], s39 offen lds
  s_add_u32 m0, s36, 88064
  s_nop 0
  buffer_load_dwordx4 v22, s[20:23], s39 offen lds
  s_add_u32 m0, s35, 57344
  s_add_u32 s42, s38, 0
  buffer_load_dwordx4 v10, s[12:15], s42 offen lds
  s_add_u32 m0, s35, 61440
  s_add_u32 s42, s38, 131072
  buffer_load_dwordx4 v10, s[12:15], s42 offen lds
  s_waitcnt vmcnt(25)
  s_barrier
  s_add_u32 s38, s37, 24
  s_and_b32 s38, s38, 31
  s_mul_i32 s39, s38, 12288
  s_add_u32 s39, s39, s32
  s_lshl_b32 s38, s38, 7
  s_add_u32 s38, s38, s33
  s_add_u32 m0, s36, 0
  s_nop 0
  buffer_load_dwordx4 v20, s[20:23], s39 offen lds
  s_add_u32 m0, s36, 1024
  s_nop 0
  buffer_load_dwordx4 v21, s[20:23], s39 offen lds
  s_add_u32 m0, s36, 2048
  s_nop 0
  buffer_load_dwordx4 v22, s[20:23], s39 offen lds
  s_add_u32 m0, s35, 0
  s_add_u32 s42, s38, 0
  buffer_load_dwordx4 v10, s[12:15], s42 offen lds
  s_add_u32 m0, s35, 4096
  s_add_u32 s42, s38, 131072
  buffer_load_dwordx4 v10, s[12:15], s42 offen lds
  s_waitcnt vmcnt(25)
  s_barrier
  s_add_u32 s38, s37, 25
  s_and_b32 s38, s38, 31
  s_mul_i32 s39, s38, 12288
  s_add_u32 s39, s39, s32
  s_lshl_b32 s38, s38, 7
  s_add_u32 s38, s38, s33
  s_add_u32 m0, s36, 12288
  s_nop 0
  buffer_load_dwordx4 v20, s[20:23], s39 offen lds
  s_add_u32 m0, s36, 13312
  s_nop 0
  buffer_load_dwordx4 v21, s[20:23], s39 offen lds
  s_add_u32 m0, s36, 14336
  s_nop 0
  buffer_load_dwordx4 v22, s[20:23], s39 offen lds
  s_add_u32 m0, s35, 8192
  s_add_u32 s42, s38, 0
  buffer_load_dwordx4 v10, s[12:15], s42 offen lds
  s_add_u32 m0, s35, 12288
  s_add_u32 s42, s38, 131072
  buffer_load_dwordx4 v10, s[12:15], s42 offen lds
  s_waitcnt vmcnt(25)
  s_barrier
  s_add_u32 s38, s37, 26
  s_and_b32 s38, s38, 31
  s_mul_i32 s39, s38, 12288
  s_add_u32 s39, s39, s32
  s_lshl_b32 s38, s38, 7
  s_add_u32 s38, s38, s33
  s_add_u32 m0, s36, 24576
  s_nop 0
  buffer_load_dwordx4 v20, s[20:23], s39 offen lds
  s_add_u32 m0, s36, 25600
  s_nop 0
  buffer_load_dwordx4 v21, s[20:23], s39 offen lds
  s_add_u32 m0, s36, 26624
  s_nop 0
  buffer_load_dwordx4 v22, s[20:23], s39 offen lds
  s_add_u32 m0, s35, 16384
  s_add_u32 s42, s38, 0
  buffer_load_dwordx4 v10, s[12:15], s42 offen lds
  s_add_u32 m0, s35, 20480
  s_add_u32 s42, s38, 131072
  buffer_load_dwordx4 v10, s[12:15], s42 offen lds
  s_waitcnt vmcnt(25)
  s_barrier
  s_add_u32 s38, s37, 27
  s_and_b32 s38, s38, 31
  s_mul_i32 s39, s38, 12288
  s_add_u32 s39, s39, s32
  s_lshl_b32 s38, s38, 7
  s_add_u32 s38, s38, s33
  s_add_u32 m0, s36, 36864
  s_nop 0
  buffer_load_dwordx4 v20, s[20:23], s39 offen lds
  s_add_u32 m0, s36, 37888
  s_nop 0
  buffer_load_dwordx4 v21, s[20:23], s39 offen lds
  s_add_u32 m0, s36, 38912
  s_nop 0
  buffer_load_dwordx4 v22, s[20:23], s39 offen lds
  s_add_u32 m0, s35, 24576
  s_add_u32 s42, s38, 0
  buffer_load_dwordx4 v10, s[12:15], s42 offen lds
  s_add_u32 m0, s35, 28672
  s_add_u32 s42, s38, 131072
  buffer_load_dwordx4 v10, s[12:15], s42 offen lds
  s_waitcnt vmcnt(25)
  s_barrier
  s_add_u32 s38, s37, 28
  s_and_b32 s38, s38, 31
  s_mul_i32 s39, s38, 12288
  s_add_u32 s39, s39, s32
  s_lshl_b32 s38, s38, 7
  s_add_u32 s38, s38, s33
  s_add_u32 m0, s36, 49152
  s_nop 0
  buffer_load_dwordx4 v20, s[20:23], s39 offen lds
  s_add_u32 m0, s36, 50176
  s_nop 0
  buffer_load_dwordx4 v21, s[20:23], s39 offen lds
  s_add_u32 m0, s36, 51200
  s_nop 0
  buffer_load_dwordx4 v22, s[20:23], s39 offen lds
  s_add_u32 m0, s35, 32768
  s_add_u32 s42, s38, 0
  buffer_load_dwordx4 v10, s[12:15], s42 offen lds
  s_add_u32 m0, s35, 36864
  s_add_u32 s42, s38, 131072
  buffer_load_dwordx4 v10, s[12:15], s42 offen lds
  s_waitcnt vmcnt(25)
  s_barrier
  s_add_u32 s38, s37, 29
  s_and_b32 s38, s38, 31
  s_mul_i32 s39, s38, 12288
  s_add_u32 s39, s39, s32
  s_lshl_b32 s38, s38, 7
  s_add_u32 s38, s38, s33
  s_add_u32 m0, s36, 61440
  s_nop 0
  buffer_load_dwordx4 v20, s[20:23], s39 offen lds
  s_add_u32 m0, s36, 62464
  s_nop 0
  buffer_load_dwordx4 v21, s[20:23], s39 offen lds
  s_add_u32 m0, s36, 63488
  s_nop 0
  buffer_load_dwordx4 v22, s[20:23], s39 offen lds
  s_add_u32 m0, s35, 40960
  s_add_u32 s42, s38, 0
  buffer_load_dwordx4 v10, s[12:15], s42 offen lds
  s_add_u32 m0, s35, 45056
  s_add_u32 s42, s38, 131072
  buffer_load_dwordx4 v10, s[12:15], s42 offen lds
  s_waitcnt vmcnt(25)
  s_barrier
  s_add_u32 s38, s37, 30
  s_and_b32 s38, s38, 31
  s_mul_i32 s39, s38, 12288
  s_add_u32 s39, s39, s32
  s_lshl_b32 s38, s38, 7
  s_add_u32 s38, s38, s33
  s_add_u32 m0, s36, 73728
  s_nop 0
  buffer_load_dwordx4 v20, s[20:23], s39 offen lds
  s_add_u32 m0, s36, 74752
  s_nop 0
  buffer_load_dwordx4 v21, s[20:23], s39 offen lds
  s_add_u32 m0, s36, 75776
  s_nop 0
  buffer_load_dwordx4 v22, s[20:23], s39 offen lds
  s_add_u32 m0, s35, 49152
  s_add_u32 s42, s38, 0
  buffer_load_dwordx4 v10, s[12:15], s42 offen lds
  s_add_u32 m0, s35, 53248
  s_add_u32 s42, s38, 131072
  buffer_load_dwordx4 v10, s[12:15], s42 offen lds
  s_waitcnt vmcnt(25)
  s_barrier
  s_add_u32 s38, s37, 31
  s_and_b32 s38, s38, 31
  s_mul_i32 s39, s38, 12288
  s_add_u32 s39, s39, s32
  s_lshl_b32 s38, s38, 7
  s_add_u32 s38, s38, s33
  s_add_u32 m0, s36, 86016
  s_nop 0
  buffer_load_dwordx4 v20, s[20:23], s39 offen lds
  s_add_u32 m0, s36, 87040
  s_nop 0
  buffer_load_dwordx4 v21, s[20:23], s39 offen lds
  s_add_u32 m0, s36, 88064
  s_nop 0
  buffer_load_dwordx4 v22, s[20:23], s39 offen lds
  s_add_u32 m0, s35, 57344
  s_add_u32 s42, s38, 0
  buffer_load_dwordx4 v10, s[12:15], s42 offen lds
  s_add_u32 m0, s35, 61440
  s_add_u32 s42, s38, 131072
  buffer_load_dwordx4 v10, s[12:15], s42 offen lds
  s_waitcnt vmcnt(25)
  s_barrier
  s_waitcnt vmcnt(20)
  s_barrier
  s_waitcnt vmcnt(15)
  s_barrier
  s_waitcnt vmcnt(10)
  s_barrier
  s_waitcnt vmcnt(5)
  s_barrier
  s_waitcnt vmcnt(0)
  s_barrier
k2_end:
  s_endpgm
.globl gated_mix__sliding_local_dilated__mixer_gmlp__prompt_kernel
.p2align 8
.type gated_mix__sliding_local_dilated__mixer_gmlp__prompt_kernel,@function
gated_mix__sliding_local_dilated__mixer_gmlp__prompt_kernel:
  s_cmp_ge_u32 s2, 256
  s_cbranch_scc1 k3_end
  s_load_dwordx2 s[4:5], s[0:1], 16
  s_load_dwordx2 s[6:7], s[0:1], 56
  s_load_dwordx2 s[8:9], s[0:1], 72
  s_load_dwordx2 s[10:11], s[0:1], 88
  v_and_b32 v1, 63, v0
  v_lshrrev_b32 v2, 6, v0
  s_nop 0
  v_readfirstlane_b32 s24, v2
  s_and_b32 s46, s2, 7
  s_lshr_b32 s47, s2, 3
  s_lshr_b32 s28, s46, 1
  s_lshl_b32 s28, s28, 3
  s_lshr_b32 s48, s47, 2
  s_add_u32 s28, s28, s48
  s_and_b32 s29, s46, 1
  s_lshl_b32 s29, s29, 2
  s_and_b32 s48, s47, 3
  s_add_u32 s29, s29, s48
  v_and_b32 v13, 15, v1
  v_lshrrev_b32 v14, 4, v1
  s_waitcnt lgkmcnt(0)
  s_mov_b32 s20, s10
  s_and_b32 s21, s11, 0xffff
  s_mov_b32 s22, 268435456
  s_mov_b32 s23, 0x00020000
  s_cmp_ge_u32 s24, 4
  s_cbranch_scc1 k3_load
  s_mov_b32 s52, s8
  s_and_b32 s53, s9, 0xffff
  s_mov_b32 s54, 2097152
  s_mov_b32 s55, 0x00020000
  s_and_b32 s25, s24, 1
  s_lshr_b32 s26, s24, 1
  v_and_b32 v6, 7, v13
  v_xor_b32 v6, v6, v14
  v_lshlrev_b32 v6, 4, v6
  v_lshl_add_u32 v6, v13, 7, v6
  s_lshl_b32 s48, s26, 12
  v_add_u32 v4, s48, v6
  v_xor_b32 v5, 64, v4
  v_add_u32 v2, 65536, v4
  v_add_u32 v3, 65536, v5
  v_bfe_u32 v6, v1, 2, 2
  v_and_b32 v7, 1, v14
  v_lshlrev_b32 v7, 1, v7
  v_lshrrev_b32 v8, 1, v6
  v_or_b32 v7, v7, v8
  v_lshlrev_b32 v7, 1, v7
  v_bfe_u32 v8, v1, 1, 1
  v_lshlrev_b32 v9, 10, v14
  v_lshl_add_u32 v9, v6, 7, v9
  v_and_b32 v6, 1, v1
  v_lshl_add_u32 v9, v6, 3, v9
  s_lshl_b32 s48, s25, 2
  s_add_u32 s49, s48, 0
  v_add_u32 v6, s49, v8
  v_xor_b32 v6, v6, v7
  v_lshl_add_u32 v10, v6, 4, v9
  v_add_u32 v100, 65536, v10
  s_add_u32 s49, s48, 2
  v_add_u32 v6, s49, v8
  v_xor_b32 v6, v6, v7
  v_lshl_add_u32 v11, v6, 4, v9
  v_add_u32 v101, 65536, v11
  v_mov_b32 v16, 0
  v_mov_b32 v17, 0
  v_mov_b32 v18, 0
  v_mov_b32 v19, 0
  v_mov_b32 v20, 0
  v_mov_b32 v21, 0
  v_mov_b32 v22, 0
  v_mov_b32 v23, 0
  v_mov_b32 v24, 0
  v_mov_b32 v25, 0
  v_mov_b32 v26, 0
  v_mov_b32 v27, 0
  v_mov_b32 v28, 0
  v_mov_b32 v29, 0
  v_mov_b32 v30, 0
  v_mov_b32 v31, 0
  v_mov_b32 v32, 0
  v_mov_b32 v33, 0
  v_mov_b32 v34, 0
  v_mov_b32 v35, 0
  v_mov_b32 v36, 0
  v_mov_b32 v37, 0
  v_mov_b32 v38, 0
  v_mov_b32 v39, 0
  v_mov_b32 v40, 0
  v_mov_b32 v41, 0
  v_mov_b32 v42, 0
  v_mov_b32 v43, 0
  v_mov_b32 v44, 0
  v_mov_b32 v45, 0
  v_mov_b32 v46, 0
  v_mov_b32 v47, 0
  s_lshl_b32 s48, s28, 6
  s_lshl_b32 s49, s26, 5
  s_add_u32 s48, s48, s49
  v_add_u32 v104, s48, v13
  v_lshlrev_b32 v105, 2, v104
  s_barrier
  ds_read_b64_tr_b16 v[48:49], v10 offset:8192
  ds_read_b64_tr_b16 v[50:51], v10 offset:8704
  ds_read_b64_tr_b16 v[52:53], v11 offset:8192
  ds_read_b64_tr_b16 v[54:55], v11 offset:8704
  ds_read_b128 v[56:59], v4 offset:0
  ds_read_b128 v[60:63], v4 offset:2048
  ds_read_b64_tr_b16 v[64:65], v10 offset:12288
  ds_read_b64_tr_b16 v[66:67], v10 offset:12800
  ds_read_b64_tr_b16 v[68:69], v11 offset:12288
  ds_read_b64_tr_b16 v[70:71], v11 offset:12800
  ds_read_b128 v[72:75], v5 offset:0
  ds_read_b128 v[76:79], v5 offset:2048
  s_barrier
  s_waitcnt lgkmcnt(6)
  v_mfma_f32_16x16x32_bf16 v[16:19], v[48:51], v[56:59], v[16:19]
  ds_read_b64_tr_b16 v[80:81], v10 offset:24576
  ds_read_b64_tr_b16 v[82:83], v10 offset:25088
  v_mfma_f32_16x16x32_bf16 v[20:23], v[48:51], v[60:63], v[20:23]
  ds_read_b64_tr_b16 v[84:85], v11 offset:24576
  ds_read_b64_tr_b16 v[86:87], v11 offset:25088
  v_mfma_f32_16x16x32_bf16 v[24:27], v[52:55], v[56:59], v[24:27]
  ds_read_b128 v[88:91], v4 offset:16384
  v_mfma_f32_16x16x32_bf16 v[28:31], v[52:55], v[60:63], v[28:31]
  ds_read_b128 v[92:95], v4 offset:18432
  s_waitcnt lgkmcnt(6)
  v_mfma_f32_16x16x32_bf16 v[16:19], v[64:67], v[72:75], v[16:19]
  ds_read_b64_tr_b16 v[48:49], v10 offset:28672
  ds_read_b64_tr_b16 v[50:51], v10 offset:29184
  v_mfma_f32_16x16x32_bf16 v[20:23], v[64:67], v[76:79], v[20:23]
  ds_read_b64_tr_b16 v[52:53], v11 offset:28672
  ds_read_b64_tr_b16 v[54:55], v11 offset:29184
  v_mfma_f32_16x16x32_bf16 v[24:27], v[68:71], v[72:75], v[24:27]
  ds_read_b128 v[56:59], v5 offset:16384
  v_mfma_f32_16x16x32_bf16 v[28:31], v[68:71], v[76:79], v[28:31]
  ds_read_b128 v[60:63], v5 offset:18432
  s_barrier
  s_waitcnt lgkmcnt(6)
  v_mfma_f32_16x16x32_bf16 v[16:19], v[80:83], v[88:91], v[16:19]
  ds_read_b64_tr_b16 v[64:65], v10 offset:40960
  ds_read_b64_tr_b16 v[66:67], v10 offset:41472
  v_mfma_f32_16x16x32_bf16 v[20:23], v[80:83], v[92:95], v[20:23]
  ds_read_b64_tr_b16 v[68:69], v11 offset:40960
  ds_read_b64_tr_b16 v[70:71], v11 offset:41472
  v_mfma_f32_16x16x32_bf16 v[24:27], v[84:87], v[88:91], v[24:27]
  ds_read_b128 v[72:75], v4 offset:32768
  v_mfma_f32_16x16x32_bf16 v[28:31], v[84:87], v[92:95], v[28:31]
  ds_read_b128 v[76:79], v4 offset:34816
  s_waitcnt lgkmcnt(6)
  v_mfma_f32_16x16x32_bf16 v[16:19], v[48:51], v[56:59], v[16:19]
  ds_read_b64_tr_b16 v[80:81], v10 offset:45056
  ds_read_b64_tr_b16 v[82:83], v10 offset:45568
  v_mfma_f32_16x16x32_bf16 v[20:23], v[48:51], v[60:63], v[20:23]
  ds_read_b64_tr_b16 v[84:85], v11 offset:45056
  ds_read_b64_tr_b16 v[86:87], v11 offset:45568
  v_mfma_f32_16x16x32_bf16 v[24:27], v[52:55], v[56:59], v[24:27]
  ds_read_b128 v[88:91], v5 offset:32768
  v_mfma_f32_16x16x32_bf16 v[28:31], v[52:55], v[60:63], v[28:31]
  ds_read_b128 v[92:95], v5 offset:34816
  s_barrier
  s_waitcnt lgkmcnt(6)
  v_mfma_f32_16x16x32_bf16 v[16:19], v[64:67], v[72:75], v[16:19]
  ds_read_b64_tr_b16 v[48:49], v10 offset:57344
  ds_read_b64_tr_b16 v[50:51], v10 offset:57856
  v_mfma_f32_16x16x32_bf16 v[20:23], v[64:67], v[76:79], v[20:23]
  ds_read_b64_tr_b16 v[52:53], v11 offset:57344
  ds_read_b64_tr_b16 v[54:55], v11 offset:57856
  v_mfma_f32_16x16x32_bf16 v[24:27], v[68:71], v[72:75], v[24:27]
  ds_read_b128 v[56:59], v4 offset:49152
  v_mfma_f32_16x16x32_bf16 v[28:31], v[68:71], v[76:79], v[28:31]
  ds_read_b128 v[60:63], v4 offset:51200
  s_waitcnt lgkmcnt(6)
  v_mfma_f32_16x16x32_bf16 v[16:19], v[80:83], v[88:91], v[16:19]
  ds_read_b64_tr_b16 v[64:65], v10 offset:61440
  ds_read_b64_tr_b16 v[66:67], v10 offset:61952
  v_mfma_f32_16x16x32_bf16 v[20:23], v[80:83], v[92:95], v[20:23]
  ds_read_b64_tr_b16 v[68:69], v11 offset:61440
  ds_read_b64_tr_b16 v[70:71], v11 offset:61952
  v_mfma_f32_16x16x32_bf16 v[24:27], v[84:87], v[88:91], v[24:27]
  ds_read_b128 v[72:75], v5 offset:49152
  v_mfma_f32_16x16x32_bf16 v[28:31], v[84:87], v[92:95], v[28:31]
  ds_read_b128 v[76:79], v5 offset:51200
  s_barrier
  s_waitcnt lgkmcnt(6)
  v_mfma_f32_16x16x32_bf16 v[16:19], v[48:51], v[56:59], v[16:19]
  ds_read_b64_tr_b16 v[80:81], v100 offset:8192
  ds_read_b64_tr_b16 v[82:83], v100 offset:8704
  v_mfma_f32_16x16x32_bf16 v[20:23], v[48:51], v[60:63], v[20:23]
  ds_read_b64_tr_b16 v[84:85], v101 offset:8192
  ds_read_b64_tr_b16 v[86:87], v101 offset:8704
  v_mfma_f32_16x16x32_bf16 v[24:27], v[52:55], v[56:59], v[24:27]
  ds_read_b128 v[88:91], v2 offset:0
  v_mfma_f32_16x16x32_bf16 v[28:31], v[52:55], v[60:63], v[28:31]
  ds_read_b128 v[92:95], v2 offset:2048
  s_waitcnt lgkmcnt(6)
  v_mfma_f32_16x16x32_bf16 v[16:19], v[64:67], v[72:75], v[16:19]
  ds_read_b64_tr_b16 v[48:49], v100 offset:12288
  ds_read_b64_tr_b16 v[50:51], v100 offset:12800
  v_mfma_f32_16x16x32_bf16 v[20:23], v[64:67], v[76:79], v[20:23]
  ds_read_b64_tr_b16 v[52:53], v101 offset:12288
  ds_read_b64_tr_b16 v[54:55], v101 offset:12800
  v_mfma_f32_16x16x32_bf16 v[24:27], v[68:71], v[72:75], v[24:27]
  ds_read_b128 v[56:59], v3 offset:0
  v_mfma_f32_16x16x32_bf16 v[28:31], v[68:71], v[76:79], v[28:31]
  ds_read_b128 v[60:63], v3 offset:2048
  s_mov_b32 s48, 17825792
  buffer_load_dword v120, v105, s[20:23], s48 offen
  buffer_load_dword v121, v105, s[20:23], s48 offen offset:64
  s_barrier
  s_waitcnt lgkmcnt(6)
  v_mfma_f32_16x16x32_bf16 v[16:19], v[80:83], v[88:91], v[16:19]
  ds_read_b64_tr_b16 v[64:65], v100 offset:24576
  ds_read_b64_tr_b16 v[66:67], v100 offset:25088
  v_mfma_f32_16x16x32_bf16 v[20:23], v[80:83], v[92:95], v[20:23]
  ds_read_b64_tr_b16 v[68:69], v101 offset:24576
  ds_read_b64_tr_b16 v[70:71], v101 offset:25088
  v_mfma_f32_16x16x32_bf16 v[24:27], v[84:87], v[88:91], v[24:27]
  ds_read_b128 v[72:75], v2 offset:16384
  v_mfma_f32_16x16x32_bf16 v[28:31], v[84:87], v[92:95], v[28:31]
  ds_read_b128 v[76:79], v2 offset:18432
  s_waitcnt lgkmcnt(6)
  v_mfma_f32_16x16x32_bf16 v[16:19], v[48:51], v[56:59], v[16:19]
  ds_read_b64_tr_b16 v[80:81], v100 offset:28672
  ds_read_b64_tr_b16 v[82:83], v100 offset:29184
  v_mfma_f32_16x16x32_bf16 v[20:23], v[48:51], v[60:63], v[20:23]
  ds_read_b64_tr_b16 v[84:85], v101 offset:28672
  ds_read_b64_tr_b16 v[86:87], v101 offset:29184
  v_mfma_f32_16x16x32_bf16 v[24:27], v[52:55], v[56:59], v[24:27]
  ds_read_b128 v[88:91], v3 offset:16384
  v_mfma_f32_16x16x32_bf16 v[28:31], v[52:55], v[60:63], v[28:31]
  ds_read_b128 v[92:95], v3 offset:18432
  s_barrier
  s_waitcnt lgkmcnt(6)
  v_mfma_f32_16x16x32_bf16 v[16:19], v[64:67], v[72:75], v[16:19]
  ds_read_b64_tr_b16 v[48:49], v100 offset:40960
  ds_read_b64_tr_b16 v[50:51], v100 offset:41472
  v_mfma_f32_16x16x32_bf16 v[20:23], v[64:67], v[76:79], v[20:23]
  ds_read_b64_tr_b16 v[52:53], v101 offset:40960
  ds_read_b64_tr_b16 v[54:55], v101 offset:41472
  v_mfma_f32_16x16x32_bf16 v[24:27], v[68:71], v[72:75], v[24:27]
  ds_read_b128 v[56:59], v2 offset:32768
  v_mfma_f32_16x16x32_bf16 v[28:31], v[68:71], v[76:79], v[28:31]
  ds_read_b128 v[60:63], v2 offset:34816
  s_waitcnt lgkmcnt(6)
  v_mfma_f32_16x16x32_bf16 v[16:19], v[80:83], v[88:91], v[16:19]
  ds_read_b64_tr_b16 v[64:65], v100 offset:45056
  ds_read_b64_tr_b16 v[66:67], v100 offset:45568
  v_mfma_f32_16x16x32_bf16 v[20:23], v[80:83], v[92:95], v[20:23]
  ds_read_b64_tr_b16 v[68:69], v101 offset:45056
  ds_read_b64_tr_b16 v[70:71], v101 offset:45568
  v_mfma_f32_16x16x32_bf16 v[24:27], v[84:87], v[88:91], v[24:27]
  ds_read_b128 v[72:75], v3 offset:32768
  v_mfma_f32_16x16x32_bf16 v[28:31], v[84:87], v[92:95], v[28:31]
  ds_read_b128 v[76:79], v3 offset:34816
  s_barrier
  s_waitcnt lgkmcnt(6)
  v_mfma_f32_16x16x32_bf16 v[16:19], v[48:51], v[56:59], v[16:19]
  ds_read_b64_tr_b16 v[80:81], v100 offset:57344
  ds_read_b64_tr_b16 v[82:83], v100 offset:57856
  v_mfma_f32_16x16x32_bf16 v[20:23], v[48:51], v[60:63], v[20:23]
  ds_read_b64_tr_b16 v[84:85], v101 offset:57344
  ds_read_b64_tr_b16 v[86:87], v101 offset:57856
  v_mfma_f32_16x16x32_bf16 v[24:27], v[52:55], v[56:59], v[24:27]
  ds_read_b128 v[88:91], v2 offset:49152
  v_mfma_f32_16x16x32_bf16 v[28:31], v[52:55], v[60:63], v[28:31]
  ds_read_b128 v[92:95], v2 offset:51200
  s_waitcnt lgkmcnt(6)
  v_mfma_f32_16x16x32_bf16 v[16:19], v[64:67], v[72:75], v[16:19]
  ds_read_b64_tr_b16 v[48:49], v100 offset:61440
  ds_read_b64_tr_b16 v[50:51], v100 offset:61952
  v_mfma_f32_16x16x32_bf16 v[20:23], v[64:67], v[76:79], v[20:23]
  ds_read_b64_tr_b16 v[52:53], v101 offset:61440
  ds_read_b64_tr_b16 v[54:55], v101 offset:61952
  v_mfma_f32_16x16x32_bf16 v[24:27], v[68:71], v[72:75], v[24:27]
  ds_read_b128 v[56:59], v3 offset:49152
  v_mfma_f32_16x16x32_bf16 v[28:31], v[68:71], v[76:79], v[28:31]
  ds_read_b128 v[60:63], v3 offset:51200
  s_barrier
  s_waitcnt lgkmcnt(6)
  v_mfma_f32_16x16x32_bf16 v[16:19], v[80:83], v[88:91], v[16:19]
  ds_read_b64_tr_b16 v[64:65], v10 offset:8192
  ds_read_b64_tr_b16 v[66:67], v10 offset:8704
  v_mfma_f32_16x16x32_bf16 v[20:23], v[80:83], v[92:95], v[20:23]
  ds_read_b64_tr_b16 v[68:69], v11 offset:8192
  ds_read_b64_tr_b16 v[70:71], v11 offset:8704
  v_mfma_f32_16x16x32_bf16 v[24:27], v[84:87], v[88:91], v[24:27]
  ds_read_b128 v[72:75], v4 offset:0
  v_mfma_f32_16x16x32_bf16 v[28:31], v[84:87], v[92:95], v[28:31]
  ds_read_b128 v[76:79], v4 offset:2048
  s_waitcnt lgkmcnt(6)
  v_mfma_f32_16x16x32_bf16 v[16:19], v[48:51], v[56:59], v[16:19]
  ds_read_b64_tr_b16 v[80:81], v10 offset:12288
  ds_read_b64_tr_b16 v[82:83], v10 offset:12800
  v_mfma_f32_16x16x32_bf16 v[20:23], v[48:51], v[60:63], v[20:23]
  ds_read_b64_tr_b16 v[84:85], v11 offset:12288
  ds_read_b64_tr_b16 v[86:87], v11 offset:12800
  v_mfma_f32_16x16x32_bf16 v[24:27], v[52:55], v[56:59], v[24:27]
  ds_read_b128 v[88:91], v5 offset:0
  v_mfma_f32_16x16x32_bf16 v[28:31], v[52:55], v[60:63], v[28:31]
  ds_read_b128 v[92:95], v5 offset:2048
  s_barrier
  s_waitcnt lgkmcnt(6)
  v_mfma_f32_16x16x32_bf16 v[32:35], v[64:67], v[72:75], v[32:35]
  ds_read_b64_tr_b16 v[48:49], v10 offset:24576
  ds_read_b64_tr_b16 v[50:51], v10 offset:25088
  v_mfma_f32_16x16x32_bf16 v[36:39], v[64:67], v[76:79], v[36:39]
  ds_read_b64_tr_b16 v[52:53], v11 offset:24576
  ds_read_b64_tr_b16 v[54:55], v11 offset:25088
  v_mfma_f32_16x16x32_bf16 v[40:43], v[68:71], v[72:75], v[40:43]
  ds_read_b128 v[56:59], v4 offset:16384
  v_mfma_f32_16x16x32_bf16 v[44:47], v[68:71], v[76:79], v[44:47]
  ds_read_b128 v[60:63], v4 offset:18432
  s_waitcnt lgkmcnt(6)
  v_mfma_f32_16x16x32_bf16 v[32:35], v[80:83], v[88:91], v[32:35]
  ds_read_b64_tr_b16 v[64:65], v10 offset:28672
  ds_read_b64_tr_b16 v[66:67], v10 offset:29184
  v_mfma_f32_16x16x32_bf16 v[36:39], v[80:83], v[92:95], v[36:39]
  ds_read_b64_tr_b16 v[68:69], v11 offset:28672
  ds_read_b64_tr_b16 v[70:71], v11 offset:29184
  v_mfma_f32_16x16x32_bf16 v[40:43], v[84:87], v[88:91], v[40:43]
  ds_read_b128 v[72:75], v5 offset:16384
  v_mfma_f32_16x16x32_bf16 v[44:47], v[84:87], v[92:95], v[44:47]
  ds_read_b128 v[76:79], v5 offset:18432
  s_barrier
  s_waitcnt lgkmcnt(6)
  v_mfma_f32_16x16x32_bf16 v[32:35], v[48:51], v[56:59], v[32:35]
  ds_read_b64_tr_b16 v[80:81], v10 offset:40960
  ds_read_b64_tr_b16 v[82:83], v10 offset:41472
  v_mfma_f32_16x16x32_bf16 v[36:39], v[48:51], v[60:63], v[36:39]
  ds_read_b64_tr_b16 v[84:85], v11 offset:40960
  ds_read_b64_tr_b16 v[86:87], v11 offset:41472
  v_mfma_f32_16x16x32_bf16 v[40:43], v[52:55], v[56:59], v[40:43]
  ds_read_b128 v[88:91], v4 offset:32768
  v_mfma_f32_16x16x32_bf16 v[44:47], v[52:55], v[60:63], v[44:47]
  ds_read_b128 v[92:95], v4 offset:34816
  s_waitcnt lgkmcnt(6)
  v_mfma_f32_16x16x32_bf16 v[32:35], v[64:67], v[72:75], v[32:35]
  ds_read_b64_tr_b16 v[48:49], v10 offset:45056
  ds_read_b64_tr_b16 v[50:51], v10 offset:45568
  v_mfma_f32_16x16x32_bf16 v[36:39], v[64:67], v[76:79], v[36:39]
  ds_read_b64_tr_b16 v[52:53], v11 offset:45056
  ds_read_b64_tr_b16 v[54:55], v11 offset:45568
  v_mfma_f32_16x16x32_bf16 v[40:43], v[68:71], v[72:75], v[40:43]
  ds_read_b128 v[56:59], v5 offset:32768
  v_mfma_f32_16x16x32_bf16 v[44:47], v[68:71], v[76:79], v[44:47]
  ds_read_b128 v[60:63], v5 offset:34816
  s_barrier
  s_waitcnt lgkmcnt(6)
  v_mfma_f32_16x16x32_bf16 v[32:35], v[80:83], v[88:91], v[32:35]
  ds_read_b64_tr_b16 v[64:65], v10 offset:57344
  ds_read_b64_tr_b16 v[66:67], v10 offset:57856
  v_mfma_f32_16x16x32_bf16 v[36:39], v[80:83], v[92:95], v[36:39]
  ds_read_b64_tr_b16 v[68:69], v11 offset:57344
  ds_read_b64_tr_b16 v[70:71], v11 offset:57856
  v_mfma_f32_16x16x32_bf16 v[40:43], v[84:87], v[88:91], v[40:43]
  ds_read_b128 v[72:75], v4 offset:49152
  v_mfma_f32_16x16x32_bf16 v[44:47], v[84:87], v[92:95], v[44:47]
  ds_read_b128 v[76:79], v4 offset:51200
  s_waitcnt lgkmcnt(6)
  v_mfma_f32_16x16x32_bf16 v[32:35], v[48:51], v[56:59], v[32:35]
  ds_read_b64_tr_b16 v[80:81], v10 offset:61440
  ds_read_b64_tr_b16 v[82:83], v10 offset:61952
  v_mfma_f32_16x16x32_bf16 v[36:39], v[48:51], v[60:63], v[36:39]
  ds_read_b64_tr_b16 v[84:85], v11 offset:61440
  ds_read_b64_tr_b16 v[86:87], v11 offset:61952
  v_mfma_f32_16x16x32_bf16 v[40:43], v[52:55], v[56:59], v[40:43]
  ds_read_b128 v[88:91], v5 offset:49152
  v_mfma_f32_16x16x32_bf16 v[44:47], v[52:55], v[60:63], v[44:47]
  ds_read_b128 v[92:95], v5 offset:51200
  s_barrier
  s_waitcnt lgkmcnt(6)
  v_mfma_f32_16x16x32_bf16 v[32:35], v[64:67], v[72:75], v[32:35]
  ds_read_b64_tr_b16 v[48:49], v100 offset:8192
  ds_read_b64_tr_b16 v[50:51], v100 offset:8704
  v_mfma_f32_16x16x32_bf16 v[36:39], v[64:67], v[76:79], v[36:39]
  ds_read_b64_tr_b16 v[52:53], v101 offset:8192
  ds_read_b64_tr_b16 v[54:55], v101 offset:8704
  v_mfma_f32_16x16x32_bf16 v[40:43], v[68:71], v[72:75], v[40:43]
  ds_read_b128 v[56:59], v2 offset:0
  v_mfma_f32_16x16x32_bf16 v[44:47], v[68:71], v[76:79], v[44:47]
  ds_read_b128 v[60:63], v2 offset:2048
  s_waitcnt lgkmcnt(6)
  v_mfma_f32_16x16x32_bf16 v[32:35], v[80:83], v[88:91], v[32:35]
  ds_read_b64_tr_b16 v[64:65], v100 offset:12288
  ds_read_b64_tr_b16 v[66:67], v100 offset:12800
  v_mfma_f32_16x16x32_bf16 v[36:39], v[80:83], v[92:95], v[36:39]
  ds_read_b64_tr_b16 v[68:69], v101 offset:12288
  ds_read_b64_tr_b16 v[70:71], v101 offset:12800
  v_mfma_f32_16x16x32_bf16 v[40:43], v[84:87], v[88:91], v[40:43]
  ds_read_b128 v[72:75], v3 offset:0
  v_mfma_f32_16x16x32_bf16 v[44:47], v[84:87], v[92:95], v[44:47]
  ds_read_b128 v[76:79], v3 offset:2048
  s_barrier
  s_waitcnt lgkmcnt(6)
  v_mfma_f32_16x16x32_bf16 v[32:35], v[48:51], v[56:59], v[32:35]
  ds_read_b64_tr_b16 v[80:81], v100 offset:24576
  ds_read_b64_tr_b16 v[82:83], v100 offset:25088
  v_mfma_f32_16x16x32_bf16 v[36:39], v[48:51], v[60:63], v[36:39]
  ds_read_b64_tr_b16 v[84:85], v101 offset:24576
  ds_read_b64_tr_b16 v[86:87], v101 offset:25088
  v_mfma_f32_16x16x32_bf16 v[40:43], v[52:55], v[56:59], v[40:43]
  ds_read_b128 v[88:91], v2 offset:16384
  v_mfma_f32_16x16x32_bf16 v[44:47], v[52:55], v[60:63], v[44:47]
  ds_read_b128 v[92:95], v2 offset:18432
  s_waitcnt lgkmcnt(6)
  v_mfma_f32_16x16x32_bf16 v[32:35], v[64:67], v[72:75], v[32:35]
  ds_read_b64_tr_b16 v[48:49], v100 offset:28672
  ds_read_b64_tr_b16 v[50:51], v100 offset:29184
  v_mfma_f32_16x16x32_bf16 v[36:39], v[64:67], v[76:79], v[36:39]
  ds_read_b64_tr_b16 v[52:53], v101 offset:28672
  ds_read_b64_tr_b16 v[54:55], v101 offset:29184
  v_mfma_f32_16x16x32_bf16 v[40:43], v[68:71], v[72:75], v[40:43]
  ds_read_b128 v[56:59], v3 offset:16384
  v_mfma_f32_16x16x32_bf16 v[44:47], v[68:71], v[76:79], v[44:47]
  ds_read_b128 v[60:63], v3 offset:18432
  s_barrier
  s_waitcnt lgkmcnt(6)
  v_mfma_f32_16x16x32_bf16 v[32:35], v[80:83], v[88:91], v[32:35]
  ds_read_b64_tr_b16 v[64:65], v100 offset:40960
  ds_read_b64_tr_b16 v[66:67], v100 offset:41472
  v_mfma_f32_16x16x32_bf16 v[36:39], v[80:83], v[92:95], v[36:39]
  ds_read_b64_tr_b16 v[68:69], v101 offset:40960
  ds_read_b64_tr_b16 v[70:71], v101 offset:41472
  v_mfma_f32_16x16x32_bf16 v[40:43], v[84:87], v[88:91], v[40:43]
  ds_read_b128 v[72:75], v2 offset:32768
  v_mfma_f32_16x16x32_bf16 v[44:47], v[84:87], v[92:95], v[44:47]
  ds_read_b128 v[76:79], v2 offset:34816
  s_waitcnt lgkmcnt(6)
  v_mfma_f32_16x16x32_bf16 v[32:35], v[48:51], v[56:59], v[32:35]
  ds_read_b64_tr_b16 v[80:81], v100 offset:45056
  ds_read_b64_tr_b16 v[82:83], v100 offset:45568
  v_mfma_f32_16x16x32_bf16 v[36:39], v[48:51], v[60:63], v[36:39]
  ds_read_b64_tr_b16 v[84:85], v101 offset:45056
  ds_read_b64_tr_b16 v[86:87], v101 offset:45568
  v_mfma_f32_16x16x32_bf16 v[40:43], v[52:55], v[56:59], v[40:43]
  ds_read_b128 v[88:91], v3 offset:32768
  v_mfma_f32_16x16x32_bf16 v[44:47], v[52:55], v[60:63], v[44:47]
  ds_read_b128 v[92:95], v3 offset:34816
  s_barrier
  s_waitcnt lgkmcnt(6)
  v_mfma_f32_16x16x32_bf16 v[32:35], v[64:67], v[72:75], v[32:35]
  ds_read_b64_tr_b16 v[48:49], v100 offset:57344
  ds_read_b64_tr_b16 v[50:51], v100 offset:57856
  v_mfma_f32_16x16x32_bf16 v[36:39], v[64:67], v[76:79], v[36:39]
  ds_read_b64_tr_b16 v[52:53], v101 offset:57344
  ds_read_b64_tr_b16 v[54:55], v101 offset:57856
  v_mfma_f32_16x16x32_bf16 v[40:43], v[68:71], v[72:75], v[40:43]
  ds_read_b128 v[56:59], v2 offset:49152
  v_mfma_f32_16x16x32_bf16 v[44:47], v[68:71], v[76:79], v[44:47]
  ds_read_b128 v[60:63], v2 offset:51200
  s_waitcnt lgkmcnt(6)
  v_mfma_f32_16x16x32_bf16 v[32:35], v[80:83], v[88:91], v[32:35]
  ds_read_b64_tr_b16 v[64:65], v100 offset:61440
  ds_read_b64_tr_b16 v[66:67], v100 offset:61952
  v_mfma_f32_16x16x32_bf16 v[36:39], v[80:83], v[92:95], v[36:39]
  ds_read_b64_tr_b16 v[68:69], v101 offset:61440
  ds_read_b64_tr_b16 v[70:71], v101 offset:61952
  v_mfma_f32_16x16x32_bf16 v[40:43], v[84:87], v[88:91], v[40:43]
  ds_read_b128 v[72:75], v3 offset:49152
  v_mfma_f32_16x16x32_bf16 v[44:47], v[84:87], v[92:95], v[44:47]
  ds_read_b128 v[76:79], v3 offset:51200
  s_barrier
  s_waitcnt lgkmcnt(6)
  v_mfma_f32_16x16x32_bf16 v[32:35], v[48:51], v[56:59], v[32:35]
  ds_read_b64_tr_b16 v[80:81], v10 offset:8192
  ds_read_b64_tr_b16 v[82:83], v10 offset:8704
  v_mfma_f32_16x16x32_bf16 v[36:39], v[48:51], v[60:63], v[36:39]
  ds_read_b64_tr_b16 v[84:85], v11 offset:8192
  ds_read_b64_tr_b16 v[86:87], v11 offset:8704
  v_mfma_f32_16x16x32_bf16 v[40:43], v[52:55], v[56:59], v[40:43]
  ds_read_b128 v[88:91], v4 offset:0
  v_mfma_f32_16x16x32_bf16 v[44:47], v[52:55], v[60:63], v[44:47]
  ds_read_b128 v[92:95], v4 offset:2048
  s_waitcnt lgkmcnt(6)
  v_mfma_f32_16x16x32_bf16 v[32:35], v[64:67], v[72:75], v[32:35]
  ds_read_b64_tr_b16 v[48:49], v10 offset:12288
  ds_read_b64_tr_b16 v[50:51], v10 offset:12800
  v_mfma_f32_16x16x32_bf16 v[36:39], v[64:67], v[76:79], v[36:39]
  ds_read_b64_tr_b16 v[52:53], v11 offset:12288
  ds_read_b64_tr_b16 v[54:55], v11 offset:12800
  v_mfma_f32_16x16x32_bf16 v[40:43], v[68:71], v[72:75], v[40:43]
  ds_read_b128 v[56:59], v5 offset:0
  v_mfma_f32_16x16x32_bf16 v[44:47], v[68:71], v[76:79], v[44:47]
  ds_read_b128 v[60:63], v5 offset:2048
  s_barrier
  s_waitcnt lgkmcnt(6)
  v_mfma_f32_16x16x32_bf16 v[32:35], v[80:83], v[88:91], v[32:35]
  ds_read_b64_tr_b16 v[64:65], v10 offset:24576
  ds_read_b64_tr_b16 v[66:67], v10 offset:25088
  v_mfma_f32_16x16x32_bf16 v[36:39], v[80:83], v[92:95], v[36:39]
  ds_read_b64_tr_b16 v[68:69], v11 offset:24576
  ds_read_b64_tr_b16 v[70:71], v11 offset:25088
  v_mfma_f32_16x16x32_bf16 v[40:43], v[84:87], v[88:91], v[40:43]
  ds_read_b128 v[72:75], v4 offset:16384
  v_mfma_f32_16x16x32_bf16 v[44:47], v[84:87], v[92:95], v[44:47]
  ds_read_b128 v[76:79], v4 offset:18432
  s_waitcnt lgkmcnt(6)
  v_mfma_f32_16x16x32_bf16 v[32:35], v[48:51], v[56:59], v[32:35]
  ds_read_b64_tr_b16 v[80:81], v10 offset:28672
  ds_read_b64_tr_b16 v[82:83], v10 offset:29184
  v_mfma_f32_16x16x32_bf16 v[36:39], v[48:51], v[60:63], v[36:39]
  ds_read_b64_tr_b16 v[84:85], v11 offset:28672
  ds_read_b64_tr_b16 v[86:87], v11 offset:29184
  v_mfma_f32_16x16x32_bf16 v[40:43], v[52:55], v[56:59], v[40:43]
  ds_read_b128 v[88:91], v5 offset:16384
  v_mfma_f32_16x16x32_bf16 v[44:47], v[52:55], v[60:63], v[44:47]
  ds_read_b128 v[92:95], v5 offset:18432
  s_barrier
  s_waitcnt lgkmcnt(6)
  v_mfma_f32_16x16x32_bf16 v[32:35], v[64:67], v[72:75], v[32:35]
  ds_read_b64_tr_b16 v[48:49], v10 offset:40960
  ds_read_b64_tr_b16 v[50:51], v10 offset:41472
  v_mfma_f32_16x16x32_bf16 v[36:39], v[64:67], v[76:79], v[36:39]
  ds_read_b64_tr_b16 v[52:53], v11 offset:40960
  ds_read_b64_tr_b16 v[54:55], v11 offset:41472
  v_mfma_f32_16x16x32_bf16 v[40:43], v[68:71], v[72:75], v[40:43]
  ds_read_b128 v[56:59], v4 offset:32768
  v_mfma_f32_16x16x32_bf16 v[44:47], v[68:71], v[76:79], v[44:47]
  ds_read_b128 v[60:63], v4 offset:34816
  s_waitcnt lgkmcnt(6)
  v_mfma_f32_16x16x32_bf16 v[32:35], v[80:83], v[88:91], v[32:35]
  ds_read_b64_tr_b16 v[64:65], v10 offset:45056
  ds_read_b64_tr_b16 v[66:67], v10 offset:45568
  v_mfma_f32_16x16x32_bf16 v[36:39], v[80:83], v[92:95], v[36:39]
  ds_read_b64_tr_b16 v[68:69], v11 offset:45056
  ds_read_b64_tr_b16 v[70:71], v11 offset:45568
  v_mfma_f32_16x16x32_bf16 v[40:43], v[84:87], v[88:91], v[40:43]
  ds_read_b128 v[72:75], v5 offset:32768
  v_mfma_f32_16x16x32_bf16 v[44:47], v[84:87], v[92:95], v[44:47]
  ds_read_b128 v[76:79], v5 offset:34816
  s_waitcnt lgkmcnt(6)
  v_mfma_f32_16x16x32_bf16 v[32:35], v[48:51], v[56:59], v[32:35]
  v_mfma_f32_16x16x32_bf16 v[36:39], v[48:51], v[60:63], v[36:39]
  v_mfma_f32_16x16x32_bf16 v[40:43], v[52:55], v[56:59], v[40:43]
  v_mfma_f32_16x16x32_bf16 v[44:47], v[52:55], v[60:63], v[44:47]
  s_waitcnt lgkmcnt(0)
  v_mfma_f32_16x16x32_bf16 v[32:35], v[64:67], v[72:75], v[32:35]
  v_mfma_f32_16x16x32_bf16 v[36:39], v[64:67], v[76:79], v[36:39]
  v_mfma_f32_16x16x32_bf16 v[40:43], v[68:71], v[72:75], v[40:43]
  v_mfma_f32_16x16x32_bf16 v[44:47], v[68:71], v[76:79], v[44:47]
  s_waitcnt vmcnt(0)
  s_nop 7
  v_sub_f32 v122, 1.0, v120
  v_sub_f32 v123, 1.0, v121
  v_lshlrev_b32 v105, 10, v104
  v_lshl_add_u32 v105, v14, 3, v105
  s_lshl_b32 s48, s29, 7
  s_lshl_b32 s49, s25, 6
  s_add_u32 s48, s48, s49
  v_mul_f32 v16, v16, v120
  v_mul_f32 v17, v17, v120
  v_mul_f32 v18, v18, v120
  v_mul_f32 v19, v19, v120
  v_fmac_f32 v16, v32, v122
  v_fmac_f32 v17, v33, v122
  v_fmac_f32 v18, v34, v122
  v_fmac_f32 v19, v35, v122
  v_cvt_pk_bf16_f32 v16, v16, v17
  v_cvt_pk_bf16_f32 v17, v18, v19
  s_add_u32 s49, s48, 0
  buffer_store_dwordx2 v[16:17], v105, s[52:55], s49 offen offset:0
  v_mul_f32 v20, v20, v121
  v_mul_f32 v21, v21, v121
  v_mul_f32 v22, v22, v121
  v_mul_f32 v23, v23, v121
  v_fmac_f32 v20, v36, v123
  v_fmac_f32 v21, v37, v123
  v_fmac_f32 v22, v38, v123
  v_fmac_f32 v23, v39, v123
  v_cvt_pk_bf16_f32 v20, v20, v21
  v_cvt_pk_bf16_f32 v21, v22, v23
  s_add_u32 s49, s48, 16384
  buffer_store_dwordx2 v[20:21], v105, s[52:55], s49 offen offset:0
  v_mul_f32 v24, v24, v120
  v_mul_f32 v25, v25, v120
  v_mul_f32 v26, v26, v120
  v_mul_f32 v27, v27, v120
  v_fmac_f32 v24, v40, v122
  v_fmac_f32 v25, v41, v122
  v_fmac_f32 v26, v42, v122
  v_fmac_f32 v27, v43, v122
  v_cvt_pk_bf16_f32 v24, v24, v25
  v_cvt_pk_bf16_f32 v25, v26, v27
  s_add_u32 s49, s48, 0
  buffer_store_dwordx2 v[24:25], v105, s[52:55], s49 offen offset:32
  v_mul_f32 v28, v28, v121
  v_mul_f32 v29, v29, v121
  v_mul_f32 v30, v30, v121
  v_mul_f32 v31, v31, v121
  v_fmac_f32 v28, v44, v123
  v_fmac_f32 v29, v45, v123
  v_fmac_f32 v30, v46, v123
  v_fmac_f32 v31, v47, v123
  v_cvt_pk_bf16_f32 v28, v28, v29
  v_cvt_pk_bf16_f32 v29, v30, v31
  s_add_u32 s49, s48, 16384
  buffer_store_dwordx2 v[28:29], v105, s[52:55], s49 offen offset:32
  s_endpgm
k3_load:
  s_mov_b32 s12, s4
  s_and_b32 s13, s5, 0xffff
  s_mov_b32 s14, 524288
  s_mov_b32 s15, 0x00020000
  s_mov_b32 s16, s6
  s_and_b32 s17, s7, 0xffff
  s_mov_b32 s18, 704512
  s_mov_b32 s19, 0x00020000
  s_sub_u32 s25, s24, 4
  v_lshrrev_b32 v4, 3, v1
  v_and_b32 v5, 7, v1
  v_xor_b32 v5, v5, v4
  v_lshlrev_b32 v5, 4, v5
  v_lshl_add_u32 v2, v4, 10, v5
  v_mul_u32_u24 v3, 1408, v4
  v_add_u32 v3, v3, v5
  s_and_b32 s48, s25, 1
  s_lshl_b32 s48, s48, 2
  v_lshrrev_b32 v5, 4, v1
  v_and_b32 v5, 1, v5
  v_lshlrev_b32 v5, 1, v5
  v_or_b32 v5, s48, v5
  v_and_b32 v6, 7, v1
  v_xor_b32 v5, v5, v6
  v_lshlrev_b32 v5, 4, v5
  v_lshl_add_u32 v15, v4, 10, v5
  s_lshl_b32 s48, s28, 6
  s_lshl_b32 s49, s25, 3
  s_add_u32 s48, s48, s49
  s_lshl_b32 s32, s48, 10
  s_add_u32 s32, s32, 8388608
  s_mul_i32 s33, s48, 1408
  s_add_u32 s33, s33, 12582912
  s_lshl_b32 s34, s25, 13
  s_lshl_b32 s48, s29, 7
  s_add_u32 s34, s34, s48
  s_lshl_b32 s35, s25, 10
  s_add_u32 m0, s35, 0
  s_add_u32 s42, s32, 0
  buffer_load_dwordx4 v2, s[20:23], s42 offen lds
  s_add_u32 m0, s35, 4096
  s_add_u32 s42, s32, 32768
  buffer_load_dwordx4 v2, s[20:23], s42 offen lds
  s_add_u32 m0, s35, 8192
  s_add_u32 s42, s34, 0
  buffer_load_dwordx4 v15, s[12:15], s42 offen lds
  s_add_u32 m0, s35, 12288
  s_add_u32 s42, s34, 32768
  buffer_load_dwordx4 v15, s[12:15], s42 offen lds
  s_add_u32 m0, s35, 16384
  s_add_u32 s42, s32, 128
  buffer_load_dwordx4 v2, s[20:23], s42 offen lds
  s_add_u32 m0, s35, 20480
  s_add_u32 s42, s32, 32896
  buffer_load_dwordx4 v2, s[20:23], s42 offen lds
  s_add_u32 m0, s35, 24576
  s_add_u32 s42, s34, 65536
  buffer_load_dwordx4 v15, s[12:15], s42 offen lds
  s_add_u32 m0, s35, 28672
  s_add_u32 s42, s34, 98304
  buffer_load_dwordx4 v15, s[12:15], s42 offen lds
  s_waitcnt vmcnt(4)
  s_barrier
  s_add_u32 m0, s35, 32768
  s_add_u32 s42, s32, 256
  buffer_load_dwordx4 v2, s[20:23], s42 offen lds
  s_add_u32 m0, s35, 36864
  s_add_u32 s42, s32, 33024
  buffer_load_dwordx4 v2, s[20:23], s42 offen lds
  s_add_u32 m0, s35, 40960
  s_add_u32 s42, s34, 131072
  buffer_load_dwordx4 v15, s[12:15], s42 offen lds
  s_add_u32 m0, s35, 45056
  s_add_u32 s42, s34, 163840
  buffer_load_dwordx4 v15, s[12:15], s42 offen lds
  s_add_u32 m0, s35, 49152
  s_add_u32 s42, s32, 384
  buffer_load_dwordx4 v2, s[20:23], s42 offen lds
  s_add_u32 m0, s35, 53248
  s_add_u32 s42, s32, 33152
  buffer_load_dwordx4 v2, s[20:23], s42 offen lds
  s_add_u32 m0, s35, 57344
  s_add_u32 s42, s34, 196608
  buffer_load_dwordx4 v15, s[12:15], s42 offen lds
  s_add_u32 m0, s35, 61440
  s_add_u32 s42, s34, 229376
  buffer_load_dwordx4 v15, s[12:15], s42 offen lds
  s_waitcnt vmcnt(8)
  s_barrier
  s_add_u32 m0, s35, 65536
  s_add_u32 s42, s32, 512
  buffer_load_dwordx4 v2, s[20:23], s42 offen lds
  s_add_u32 m0, s35, 69632
  s_add_u32 s42, s32, 33280
  buffer_load_dwordx4 v2, s[20:23], s42 offen lds
  s_add_u32 m0, s35, 73728
  s_add_u32 s42, s34, 262144
  buffer_load_dwordx4 v15, s[12:15], s42 offen lds
  s_add_u32 m0, s35, 77824
  s_add_u32 s42, s34, 294912
  buffer_load_dwordx4 v15, s[12:15], s42 offen lds
  s_add_u32 m0, s35, 81920
  s_add_u32 s42, s32, 640
  buffer_load_dwordx4 v2, s[20:23], s42 offen lds
  s_add_u32 m0, s35, 86016
  s_add_u32 s42, s32, 33408
  buffer_load_dwordx4 v2, s[20:23], s42 offen lds
  s_add_u32 m0, s35, 90112
  s_add_u32 s42, s34, 327680
  buffer_load_dwordx4 v15, s[12:15], s42 offen lds
  s_add_u32 m0, s35, 94208
  s_add_u32 s42, s34, 360448
  buffer_load_dwordx4 v15, s[12:15], s42 offen lds
  s_waitcnt vmcnt(12)
  s_barrier
  s_add_u32 m0, s35, 98304
  s_add_u32 s42, s32, 768
  buffer_load_dwordx4 v2, s[20:23], s42 offen lds
  s_add_u32 m0, s35, 102400
  s_add_u32 s42, s32, 33536
  buffer_load_dwordx4 v2, s[20:23], s42 offen lds
  s_add_u32 m0, s35, 106496
  s_add_u32 s42, s34, 393216
  buffer_load_dwordx4 v15, s[12:15], s42 offen lds
  s_add_u32 m0, s35, 110592
  s_add_u32 s42, s34, 425984
  buffer_load_dwordx4 v15, s[12:15], s42 offen lds
  s_add_u32 m0, s35, 114688
  s_add_u32 s42, s32, 896
  buffer_load_dwordx4 v2, s[20:23], s42 offen lds
  s_add_u32 m0, s35, 118784
  s_add_u32 s42, s32, 33664
  buffer_load_dwordx4 v2, s[20:23], s42 offen lds
  s_add_u32 m0, s35, 122880
  s_add_u32 s42, s34, 458752
  buffer_load_dwordx4 v15, s[12:15], s42 offen lds
  s_add_u32 m0, s35, 126976
  s_add_u32 s42, s34, 491520
  buffer_load_dwordx4 v15, s[12:15], s42 offen lds
  s_waitcnt vmcnt(16)
  s_barrier
  s_add_u32 m0, s35, 0
  s_add_u32 s42, s33, 0
  buffer_load_dwordx4 v3, s[20:23], s42 offen lds
  s_add_u32 m0, s35, 4096
  s_add_u32 s42, s33, 45056
  buffer_load_dwordx4 v3, s[20:23], s42 offen lds
  s_add_u32 m0, s35, 8192
  s_add_u32 s42, s34, 0
  buffer_load_dwordx4 v15, s[16:19], s42 offen lds
  s_add_u32 m0, s35, 12288
  s_add_u32 s42, s34, 32768
  buffer_load_dwordx4 v15, s[16:19], s42 offen lds
  s_add_u32 m0, s35, 16384
  s_add_u32 s42, s33, 128
  buffer_load_dwordx4 v3, s[20:23], s42 offen lds
  s_add_u32 m0, s35, 20480
  s_add_u32 s42, s33, 45184
  buffer_load_dwordx4 v3, s[20:23], s42 offen lds
  s_add_u32 m0, s35, 24576
  s_add_u32 s42, s34, 65536
  buffer_load_dwordx4 v15, s[16:19], s42 offen lds
  s_add_u32 m0, s35, 28672
  s_add_u32 s42, s34, 98304
  buffer_load_dwordx4 v15, s[16:19], s42 offen lds
  s_waitcnt vmcnt(20)
  s_barrier
  s_add_u32 m0, s35, 32768
  s_add_u32 s42, s33, 256
  buffer_load_dwordx4 v3, s[20:23], s42 offen lds
  s_add_u32 m0, s35, 36864
  s_add_u32 s42, s33, 45312
  buffer_load_dwordx4 v3, s[20:23], s42 offen lds
  s_add_u32 m0, s35, 40960
  s_add_u32 s42, s34, 131072
  buffer_load_dwordx4 v15, s[16:19], s42 offen lds
  s_add_u32 m0, s35, 45056
  s_add_u32 s42, s34, 163840
  buffer_load_dwordx4 v15, s[16:19], s42 offen lds
  s_waitcnt vmcnt(20)
  s_barrier
  s_add_u32 m0, s35, 49152
  s_add_u32 s42, s33, 384
  buffer_load_dwordx4 v3, s[20:23], s42 offen lds
  s_add_u32 m0, s35, 53248
  s_add_u32 s42, s33, 45440
  buffer_load_dwordx4 v3, s[20:23], s42 offen lds
  s_add_u32 m0, s35, 57344
  s_add_u32 s42, s34, 196608
  buffer_load_dwordx4 v15, s[16:19], s42 offen lds
  s_add_u32 m0, s35, 61440
  s_add_u32 s42, s34, 229376
  buffer_load_dwordx4 v15, s[16:19], s42 offen lds
  s_waitcnt vmcnt(20)
  s_barrier
  s_add_u32 m0, s35, 65536
  s_add_u32 s42, s33, 512
  buffer_load_dwordx4 v3, s[20:23], s42 offen lds
  s_add_u32 m0, s35, 69632
  s_add_u32 s42, s33, 45568
  buffer_load_dwordx4 v3, s[20:23], s42 offen lds
  s_add_u32 m0, s35, 73728
  s_add_u32 s42, s34, 262144
  buffer_load_dwordx4 v15, s[16:19], s42 offen lds
  s_add_u32 m0, s35, 77824
  s_add_u32 s42, s34, 294912
  buffer_load_dwordx4 v15, s[16:19], s42 offen lds
  s_waitcnt vmcnt(20)
  s_barrier
  s_add_u32 m0, s35, 81920
  s_add_u32 s42, s33, 640
  buffer_load_dwordx4 v3, s[20:23], s42 offen lds
  s_add_u32 m0, s35, 86016
  s_add_u32 s42, s33, 45696
  buffer_load_dwordx4 v3, s[20:23], s42 offen lds
  s_add_u32 m0, s35, 90112
  s_add_u32 s42, s34, 327680
  buffer_load_dwordx4 v15, s[16:19], s42 offen lds
  s_add_u32 m0, s35, 94208
  s_add_u32 s42, s34, 360448
  buffer_load_dwordx4 v15, s[16:19], s42 offen lds
  s_waitcnt vmcnt(20)
  s_barrier
  s_add_u32 m0, s35, 98304
  s_add_u32 s42, s33, 768
  buffer_load_dwordx4 v3, s[20:23], s42 offen lds
  s_add_u32 m0, s35, 102400
  s_add_u32 s42, s33, 45824
  buffer_load_dwordx4 v3, s[20:23], s42 offen lds
  s_add_u32 m0, s35, 106496
  s_add_u32 s42, s34, 393216
  buffer_load_dwordx4 v15, s[16:19], s42 offen lds
  s_add_u32 m0, s35, 110592
  s_add_u32 s42, s34, 425984
  buffer_load_dwordx4 v15, s[16:19], s42 offen lds
  s_waitcnt vmcnt(20)
  s_barrier
  s_add_u32 m0, s35, 114688
  s_add_u32 s42, s33, 896
  buffer_load_dwordx4 v3, s[20:23], s42 offen lds
  s_add_u32 m0, s35, 118784
  s_add_u32 s42, s33, 45952
  buffer_load_dwordx4 v3, s[20:23], s42 offen lds
  s_add_u32 m0, s35, 122880
  s_add_u32 s42, s34, 458752
  buffer_load_dwordx4 v15, s[16:19], s42 offen lds
  s_add_u32 m0, s35, 126976
  s_add_u32 s42, s34, 491520
  buffer_load_dwordx4 v15, s[16:19], s42 offen lds
  s_waitcnt vmcnt(20)
  s_barrier
  s_add_u32 m0, s35, 0
  s_add_u32 s42, s33, 1024
  buffer_load_dwordx4 v3, s[20:23], s42 offen lds
  s_add_u32 m0, s35, 4096
  s_add_u32 s42, s33, 46080
  buffer_load_dwordx4 v3, s[20:23], s42 offen lds
  s_add_u32 m0, s35, 8192
  s_add_u32 s42, s34, 524288
  buffer_load_dwordx4 v15, s[16:19], s42 offen lds
  s_add_u32 m0, s35, 12288
  s_add_u32 s42, s34, 557056
  buffer_load_dwordx4 v15, s[16:19], s42 offen lds
  s_waitcnt vmcnt(20)
  s_barrier
  s_add_u32 m0, s35, 16384
  s_add_u32 s42, s33, 1152
  buffer_load_dwordx4 v3, s[20:23], s42 offen lds
  s_add_u32 m0, s35, 20480
  s_add_u32 s42, s33, 46208
  buffer_load_dwordx4 v3, s[20:23], s42 offen lds
  s_add_u32 m0, s35, 24576
  s_add_u32 s42, s34, 589824
  buffer_load_dwordx4 v15, s[16:19], s42 offen lds
  s_add_u32 m0, s35, 28672
  s_add_u32 s42, s34, 622592
  buffer_load_dwordx4 v15, s[16:19], s42 offen lds
  s_waitcnt vmcnt(20)
  s_barrier
  s_add_u32 m0, s35, 32768
  s_add_u32 s42, s33, 1280
  buffer_load_dwordx4 v3, s[20:23], s42 offen lds
  s_add_u32 m0, s35, 36864
  s_add_u32 s42, s33, 46336
  buffer_load_dwordx4 v3, s[20:23], s42 offen lds
  s_add_u32 m0, s35, 40960
  s_add_u32 s42, s34, 655360
  buffer_load_dwordx4 v15, s[16:19], s42 offen lds
  s_add_u32 m0, s35, 45056
  s_add_u32 s42, s34, 688128
  buffer_load_dwordx4 v15, s[16:19], s42 offen lds
  s_waitcnt vmcnt(20)
  s_barrier
  s_waitcnt vmcnt(16)
  s_barrier
  s_waitcnt vmcnt(12)
  s_barrier
  s_waitcnt vmcnt(8)
  s_barrier
  s_waitcnt vmcnt(4)
  s_barrier
  s_waitcnt vmcnt(0)
  s_barrier
k3_end:
  s_endpgm
.section .rodata,"a"
.p2align 6
.amdhsa_kernel k1_kernel
  .amdhsa_next_free_vgpr 168
  .amdhsa_next_free_sgpr 96
  .amdhsa_accum_offset 168
  .amdhsa_group_segment_fixed_size 0
  .amdhsa_kernarg_size 96
  .amdhsa_user_sgpr_count 2
  .amdhsa_user_sgpr_kernarg_segment_ptr 1
  .amdhsa_system_sgpr_workgroup_id_x 1
.end_amdhsa_kernel
.p2align 6
.amdhsa_kernel k2_kernel
  .amdhsa_next_free_vgpr 128
  .amdhsa_next_free_sgpr 96
  .amdhsa_accum_offset 128
  .amdhsa_group_segment_fixed_size 0
  .amdhsa_kernarg_size 96
  .amdhsa_user_sgpr_count 2
  .amdhsa_user_sgpr_kernarg_segment_ptr 1
  .amdhsa_system_sgpr_workgroup_id_x 1
.end_amdhsa_kernel
.p2align 6
.amdhsa_kernel gated_mix__sliding_local_dilated__mixer_gmlp__prompt_kernel
  .amdhsa_next_free_vgpr 128
  .amdhsa_next_free_sgpr 96
  .amdhsa_accum_offset 128
  .amdhsa_group_segment_fixed_size 0
  .amdhsa_kernarg_size 96
  .amdhsa_user_sgpr_count 2
  .amdhsa_user_sgpr_kernarg_segment_ptr 1
  .amdhsa_system_sgpr_workgroup_id_x 1
.end_amdhsa_kernel
```
